```python
import torch

def _softmax(x, axis=-1):
    return torch.softmax(x, dim=axis)
def _gelu(x):
    return torch.nn.functional.gelu(x, approximate="tanh")
def _silu(x):
    return torch.nn.functional.silu(x)
def _sigmoid(x):
    return torch.sigmoid(x)
def _layernorm(x, axis=-1, eps=1e-5):
    m = x.mean(dim=axis, keepdim=True)
    v = x.var(dim=axis, keepdim=True, unbiased=False)
    return (x - m) / torch.sqrt(v + eps)
def _scatter_add(tgt, idx, src, axis=0):
    return tgt.clone().index_add_(axis, idx, src)
def _segment_sum(src, seg, n):
    out = torch.zeros((n,) + src.shape[1:], dtype=src.dtype)
    return out.index_add_(0, seg, src)
def _pad(x, pw):
    flat = tuple(v for pair in reversed(pw) for v in pair)
    return torch.nn.functional.pad(x, flat)

kernel_name = 'gated_mix__sliding_block_cached__glu_gated_swiglu__decode'

def setup_inputs():

    _w = (lambda a: (lambda t: t.to(torch.bfloat16) if t.is_floating_point() else t)(torch.as_tensor(a)))
    def _A_setup():
        B, Sq, D = 1, 1, 640
        Hq, Hkv, Sk, Dh = 32, 32, 32768, 192
        assert Hq % Hkv == 0, (Hq, Hkv)
        return {
            "x": _w((lambda *s: torch.randn(*s, dtype=torch.bfloat16) * 0.05)(B, Sq, D)),
            "k_cache": _w((lambda *s: torch.randn(*s, dtype=torch.bfloat16) * 6.4)(B, Hkv, Sk, Dh)),
            "v_cache": _w((lambda *s: torch.randn(*s, dtype=torch.bfloat16) * 0.05)(B, Hkv, Sk, Dh)),
            "wq": _w((lambda *s: torch.randn(*s, dtype=torch.bfloat16) * 3.2)(D, Hq * Dh) * (D ** -0.5)),
            "wo": _w((lambda *s: torch.randn(*s, dtype=torch.bfloat16) * 0.05)(Hq * Dh, D) * ((Hq * Dh) ** -0.5)),
        }
    _A_in = _A_setup()

    def _B_setup():
        B, S, D, F = 1, 1, 640, 1536
        return {
            "x": _w((lambda *s: torch.randn(*s, dtype=torch.bfloat16) * 0.05)(B, S, D)),
            "w1": _w((lambda *s: torch.randn(*s, dtype=torch.bfloat16) * 0.4)(D, F) * (2.0 / D) ** 0.5),
            "w3": _w((lambda *s: torch.randn(*s, dtype=torch.bfloat16) * 0.4)(D, F) * (2.0 / D) ** 0.5),
            "w2": _w((lambda *s: torch.randn(*s, dtype=torch.bfloat16) * 0.4)(F, D) * (2.0 / F) ** 0.5),
        }
    _B_in = _B_setup()

    return {
        "A_x": _A_in["x"],
        "A_k_cache": _A_in["k_cache"],
        "A_v_cache": _A_in["v_cache"],
        "A_wq": _A_in["wq"],
        "A_wo": _A_in["wo"],
        "B_x": _B_in["x"],
        "B_w1": _B_in["w1"],
        "B_w3": _B_in["w3"],
        "B_w2": _B_in["w2"],
        "gate_w": _w((lambda *s: torch.randn(*s, dtype=torch.bfloat16) * 0.1)(640) * 16.0),
    }

def reference(A_x, A_k_cache, A_v_cache, A_wq, A_wo, B_x, B_w1, B_w3, B_w2, gate_w):
    def _A_ref(x, k_cache, v_cache, wq, wo):
        B, Sq, D = x.shape
        Hq, Dh = 32, 192
        Hkv, Sk = k_cache.shape[1], k_cache.shape[2]
        W = min(4096, max(256, Sk // 4))
        rep = Hq // Hkv
        q = (lambda x, *d: x.permute(*d))((x @ wq).reshape(B, Sq, Hq, Dh), 0, 2, 1, 3)
        k = (lambda x, n, axis: torch.repeat_interleave(x, n, dim=axis))(k_cache[:, :, Sk - W:, :], rep, axis=1)
        v = (lambda x, n, axis: torch.repeat_interleave(x, n, dim=axis))(v_cache[:, :, Sk - W:, :], rep, axis=1)
        scores = torch.einsum("bhqd,bhkd->bhqk", q, k) * (Dh ** -0.5)
        p = _softmax(scores, axis=-1)
        o = torch.einsum("bhqk,bhkd->bhqd", p, v)
        return (lambda x, *d: x.permute(*d))(o, 0, 2, 1, 3).reshape(B, Sq, Hq * Dh) @ wo

    def _B_ref(x, w1, w3, w2):
        gate = torch.einsum("bsd,df->bsf", x, w1)
        up = torch.einsum("bsd,df->bsf", x, w3)
        h = _silu(gate) * up
        out = torch.einsum("bsf,fd->bsd", h, w2)
        return out

    x = A_x
    g = _sigmoid((x * gate_w).sum(-1, keepdims=True))
    a = _A_ref(x, A_k_cache, A_v_cache, A_wq, A_wo)
    b = _B_ref(x, B_w1, B_w3, B_w2)
    return g * a + (1 - g) * b
```

```asm
; @launch grid=(256,1,1) block=(512,1,1) lds=35584
.amdgcn_target "amdgcn-amd-amdhsa--gfx950"
.text
.globl gated_mix__sliding_block_cached__glu_gated_swiglu__decode_kernel
.p2align 8
.type gated_mix__sliding_block_cached__glu_gated_swiglu__decode_kernel,@function
gated_mix__sliding_block_cached__glu_gated_swiglu__decode_kernel:
  s_load_dwordx2 s[44:45], s[0:1], 24
  s_load_dwordx2 s[52:53], s[0:1], 0
  s_load_dwordx4 s[16:19], s[0:1], 48
  s_cmpk_ge_u32 s2, 160
  s_cbranch_scc1 L_F
L_A:
  s_and_b32 s34, s2, 7
  s_bfe_u32 s81, s2, 0x20003
  s_lshl2_add_u32 s30, s34, s81
  s_lshr_b32 s31, s2, 5
  s_lshl_b32 s34, s31, 12
  s_add_u32 s34, s34, s30
  v_lshrrev_b32 v60, 3, v0
  v_and_b32 v54, 7, v0
  v_lshl_add_u32 v2, v60, 6, s34
  v_lshlrev_b32 v54, 4, v54
  s_movk_i32 s34, 384
  v_mad_u32_u24 v2, v2, s34, v54
  s_waitcnt lgkmcnt(0)
  global_load_dwordx4 v[232:235], v2, s[44:45] offset:0 nt
  global_load_dwordx4 v[236:239], v2, s[44:45] offset:128 nt
  global_load_dwordx4 v[240:243], v2, s[44:45] offset:256 nt
  s_lshl_b32 s35, s31, 8
  v_lshl_add_u32 v3, v60, 2, s35
  global_load_dword v48, v3, s[52:53]
  s_load_dwordx2 s[56:57], s[0:1], 96
  s_load_dwordx2 s[36:37], s[0:1], 8
  v_lshrrev_b32 v58, 6, v0
  v_bfe_u32 v59, v0, 3, 3
  v_readfirstlane_b32 s32, v58
  s_movk_i32 s9, 12288
  s_mov_b32 s46, 7864320
  s_mov_b32 s47, 0x20000
  s_load_dwordx2 s[40:41], s[0:1], 16
  s_load_dwordx2 s[48:49], s[0:1], 32
  s_load_dwordx2 s[60:61], s[0:1], 80
  s_load_dwordx2 s[10:11], s[0:1], 88
  s_mov_b32 s12, 0
  s_mul_i32 s34, s30, 12582912
  s_add_u32 s34, s34, 11010048
  v_mul_u32_u24 v1, 384, v59
  v_add3_u32 v1, v1, v54, s34
  s_mov_b32 s38, 402653184
  s_mov_b32 s39, 0x20000
  s_mov_b32 s42, 402653184
  s_mov_b32 s43, 0x20000
  s_mov_b32 s58, 4194304
  s_mov_b32 s59, 0x20000
  s_mov_b32 s50, 7864320
  s_mov_b32 s51, 0x20000
  s_mov_b32 s62, 1280
  s_mov_b32 s63, 0x20000
  s_mov_b32 s79, 0
  s_mov_b32 s17, 0
  s_getreg_b32 s8, hwreg(HW_REG_XCC_ID, 0, 4)
  s_mov_b32 s80, 0x3fb8aa3b
  s_mov_b32 s20, 0x00ff00ff
  s_mov_b32 s21, 0xff00ff00
  v_and_b32 v58, 1, v0
  v_lshlrev_b32 v58, 4, v58
  v_mov_b32 v60, 0xffff
  v_lshlrev_b32 v60, v58, v60
  v_bfe_u32 v58, v0, 1, 2
  v_cmp_eq_u32 s[22:23], 0, v58
  v_cmp_eq_u32 s[24:25], 1, v58
  v_cmp_eq_u32 s[26:27], 2, v58
  v_cmp_eq_u32 s[28:29], 3, v58
  v_cndmask_b32 v4, 0, v60, s[22:23]
  v_cndmask_b32 v5, 0, v60, s[24:25]
  v_cndmask_b32 v6, 0, v60, s[26:27]
  v_cndmask_b32 v7, 0, v60, s[28:29]
  v_lshl_add_u32 v55, v59, 10, v54
  v_lshlrev_b32 v56, 1, v54
  v_lshl_add_u32 v56, v59, 2, v56
  v_bfe_u32 v58, v0, 4, 1
  v_lshlrev_b32 v58, 4, v58
  v_lshl_add_u32 v58, v54, 1, v58
  v_bfe_u32 v60, v0, 5, 1
  s_mul_i32 s34, s32, 1568
  v_mul_u32_u24 v52, 768, v60
  v_add3_u32 v52, v52, v58, s34
  s_mul_i32 s34, s32, 96
  v_mul_u32_u24 v53, 1568, v59
  v_and_b32 v61, 7, v0
  v_mul_u32_u24 v61, 12, v61
  v_add3_u32 v53, v53, v61, s34
  s_lshl_b32 s34, s32, 7
  s_lshl_b32 s35, s30, 13
  s_add_u32 s35, s35, s34
  s_add_u32 s72, s35, 4096
  s_add_u32 s76, s35, 4096
  s_lshl_b32 s35, s31, 10
  s_add_u32 s71, s72, s35
  s_add_u32 s75, s76, s35
  s_lshl_b32 s35, s30, 10
  s_add_u32 s74, s35, 458752
  s_lshl_b32 s35, s31, 7
  s_add_u32 s73, s74, s35
  s_lshr_b32 s35, s31, 2
  s_lshl3_add_u32 s35, s35, s32
  s_and_b32 s34, s31, 3
  s_lshl2_add_u32 s35, s35, s34
  s_mul_i32 s34, s30, 53
  s_add_u32 s35, s35, s34
  s_and_b32 s34, s35, 511
  s_mul_i32 s70, s34, 3072
  s_add_u32 s35, s35, 64
  s_and_b32 s34, s35, 511
  s_mul_i32 s24, s34, 3072
  s_add_u32 s35, s35, 64
  s_and_b32 s34, s35, 511
  s_mul_i32 s25, s34, 3072
  s_add_u32 s35, s35, 64
  s_and_b32 s34, s35, 511
  s_mul_i32 s26, s34, 3072
  s_add_u32 s35, s35, 64
  s_and_b32 s34, s35, 511
  s_mul_i32 s27, s34, 3072
  s_add_u32 s35, s35, 64
  s_and_b32 s34, s35, 511
  s_mul_i32 s28, s34, 3072
  s_add_u32 s35, s35, 64
  s_and_b32 s34, s35, 511
  s_mul_i32 s29, s34, 3072
  s_add_u32 s35, s35, 64
  s_and_b32 s34, s35, 511
  s_mul_i32 s16, s34, 3072
  v_mov_b32 v40, 0
  v_mov_b32 v41, 0
  v_mov_b32 v42, 0
  v_mov_b32 v43, 0
  v_mov_b32 v44, 0
  v_mov_b32 v45, 0
  v_mov_b32 v46, 0
  v_mov_b32 v47, 0
  s_mov_b32 s14, 0x01000100
  s_mov_b32 s15, 0x03020302
  s_waitcnt lgkmcnt(0)
  s_load_dword s33, s[56:57], 0
  s_waitcnt vmcnt(1)
  buffer_load_dwordx4 v[244:247], v2, s[44:47], s9 offen offset:0 nt
  buffer_load_dwordx4 v[248:251], v2, s[44:47], s9 offen offset:128 nt
  buffer_load_dwordx4 v[252:255], v2, s[44:47], s9 offen offset:256 nt
  s_waitcnt vmcnt(3)
  v_perm_b32 v58, v48, v48, s14
  v_and_b32 v8, v58, v4
  v_and_b32 v9, v58, v5
  v_and_b32 v10, v58, v6
  v_and_b32 v11, v58, v7
  v_perm_b32 v58, v48, v48, s15
  v_and_b32 v12, v58, v4
  v_and_b32 v13, v58, v5
  v_and_b32 v14, v58, v6
  v_and_b32 v15, v58, v7
  v_mfma_f32_16x16x32_bf16 v[16:19], v[8:11], v[232:235], 0
  v_mfma_f32_16x16x32_bf16 v[20:23], v[8:11], v[236:239], 0
  v_mfma_f32_16x16x32_bf16 v[24:27], v[8:11], v[240:243], 0
  s_waitcnt vmcnt(0)
  buffer_load_dwordx4 v[64:67], v1, s[36:39], s70 offen offset:0 nt
  buffer_load_dwordx4 v[68:71], v1, s[36:39], s70 offen offset:128 nt
  buffer_load_dwordx4 v[72:75], v1, s[36:39], s70 offen offset:256 nt
  v_mfma_f32_16x16x32_bf16 v[16:19], v[12:15], v[244:247], v[16:19]
  v_mfma_f32_16x16x32_bf16 v[20:23], v[12:15], v[248:251], v[20:23]
  v_mfma_f32_16x16x32_bf16 v[24:27], v[12:15], v[252:255], v[24:27]
  s_mov_b64 exec, s[20:21]
  s_nop 4
  ds_write_b128 v52, v[16:19] offset:0
  ds_write_b128 v52, v[20:23] offset:256
  ds_write_b128 v52, v[24:27] offset:512
  s_mov_b64 exec, -1
  s_waitcnt lgkmcnt(0)
  s_add_u32 s33, s33, 0x9e3779b9
  s_barrier
  ds_read2_b32 v[58:59], v53 offset0:0 offset1:192
  ds_read2_b32 v[60:61], v53 offset0:1 offset1:193
  ds_read2_b32 v[62:63], v53 offset0:2 offset1:194
  s_add_u32 s34, s33, s8
  v_mov_b32 v51, s34
  s_waitcnt lgkmcnt(2)
  v_add_f32 v48, v58, v59
  s_waitcnt lgkmcnt(1)
  v_add_f32 v49, v60, v61
  s_waitcnt lgkmcnt(0)
  v_add_f32 v50, v62, v63
  v_permlane32_swap_b32 v48, v58
  v_permlane32_swap_b32 v49, v59
  v_permlane32_swap_b32 v50, v60
  v_add_f32 v48, v48, v58
  v_add_f32 v49, v49, v59
  v_add_f32 v50, v50, v60
  v_permlane16_swap_b32 v48, v58
  v_permlane16_swap_b32 v49, v59
  v_permlane16_swap_b32 v50, v60
  v_add_f32 v48, v48, v58
  v_add_f32 v49, v49, v59
  v_add_f32 v50, v50, v60
  v_add_f32_dpp v48, v48, v48 row_ror:8 row_mask:0xf bank_mask:0xf
  v_add_f32_dpp v49, v49, v49 row_ror:8 row_mask:0xf bank_mask:0xf
  v_add_f32_dpp v50, v50, v50 row_ror:8 row_mask:0xf bank_mask:0xf
  s_mov_b64 exec, 0xff
  buffer_store_dwordx4 v[48:51], v54, s[56:59], s71 offen
  s_lshl_b32 s34, s32, 7
  v_add_u32 v62, s34, v54
  ds_write_b128 v62, v[48:51] offset:34560
  s_mov_b64 exec, -1
  s_lshr_b32 s6, s33, 26
  s_or_b32 s6, s6, 0x43300000
  s_lshl_b32 s7, s33, 6
  s_waitcnt vmcnt(1)
  buffer_load_dwordx4 v[76:79], v1, s[36:39], s24 offen offset:0 nt
  buffer_load_dwordx4 v[80:83], v1, s[36:39], s24 offen offset:128 nt
  buffer_load_dwordx4 v[84:87], v1, s[36:39], s24 offen offset:256 nt
  s_waitcnt vmcnt(0)
  buffer_load_dwordx4 v[88:91], v1, s[36:39], s25 offen offset:0 nt
  buffer_load_dwordx4 v[92:95], v1, s[36:39], s25 offen offset:128 nt
  buffer_load_dwordx4 v[96:99], v1, s[36:39], s25 offen offset:256 nt
  s_waitcnt vmcnt(0)
  buffer_load_dwordx4 v[100:103], v1, s[36:39], s26 offen offset:0 nt
  buffer_load_dwordx4 v[104:107], v1, s[36:39], s26 offen offset:128 nt
  buffer_load_dwordx4 v[108:111], v1, s[36:39], s26 offen offset:256 nt
  s_waitcnt vmcnt(0)
  buffer_load_dwordx4 v[112:115], v1, s[36:39], s27 offen offset:0 nt
  buffer_load_dwordx4 v[116:119], v1, s[36:39], s27 offen offset:128 nt
  buffer_load_dwordx4 v[120:123], v1, s[36:39], s27 offen offset:256 nt
  v_mov_b32 v48, 0
  v_mov_b32 v49, 0
  v_mov_b32 v50, 0
  s_mov_b32 exec_hi, 0xff
  buffer_load_dwordx4 v[48:51], v55, s[56:59], s72 offen sc1
  s_mov_b64 exec, -1
  s_waitcnt vmcnt(1)
  buffer_load_dwordx4 v[124:127], v1, s[36:39], s28 offen offset:0 nt
  buffer_load_dwordx4 v[128:131], v1, s[36:39], s28 offen offset:128 nt
  buffer_load_dwordx4 v[132:135], v1, s[36:39], s28 offen offset:256 nt
  s_waitcnt vmcnt(0)
  buffer_load_dwordx4 v[136:139], v1, s[36:39], s29 offen offset:0 nt
  buffer_load_dwordx4 v[140:143], v1, s[36:39], s29 offen offset:128 nt
  buffer_load_dwordx4 v[144:147], v1, s[36:39], s29 offen offset:256 nt
  s_mov_b32 exec_hi, 0xff
L_A_qpoll_chk:
  v_subrev_u32 v58, s33, v51
  v_cmp_lt_u32 vcc, 15, v58
  s_cbranch_vccnz L_A_qpoll_retry
  v_cmp_ne_u32 vcc, s8, v58
  s_mov_b32 s3, 1
  s_cbranch_vccnz L_A_qpoll_remote
L_A_qpoll_back:
  s_mov_b64 exec, -1
  ds_bpermute_b32 v58, v56, v48
  ds_bpermute_b32 v59, v56, v49
  ds_bpermute_b32 v60, v56, v50
  s_waitcnt lgkmcnt(0)
  v_add_f32_dpp v58, v58, v58 quad_perm:[1,0,3,2] row_mask:0xf bank_mask:0xf
  v_add_f32_dpp v59, v59, v59 quad_perm:[1,0,3,2] row_mask:0xf bank_mask:0xf
  v_add_f32_dpp v60, v60, v60 quad_perm:[1,0,3,2] row_mask:0xf bank_mask:0xf
  v_add_f32_dpp v58, v58, v58 quad_perm:[2,3,0,1] row_mask:0xf bank_mask:0xf
  v_add_f32_dpp v59, v59, v59 quad_perm:[2,3,0,1] row_mask:0xf bank_mask:0xf
  v_add_f32_dpp v60, v60, v60 quad_perm:[2,3,0,1] row_mask:0xf bank_mask:0xf
  v_add_f32_dpp v58, v58, v58 row_half_mirror row_mask:0xf bank_mask:0xf
  v_add_f32_dpp v59, v59, v59 row_half_mirror row_mask:0xf bank_mask:0xf
  v_add_f32_dpp v60, v60, v60 row_half_mirror row_mask:0xf bank_mask:0xf
  v_cvt_pk_bf16_f32 v58, v58, v59
  v_cvt_pk_bf16_f32 v59, v60, v60
  v_lshrrev_b32 v60, 3, v0
  v_mul_u32_u24 v60, 6, v60
  s_mov_b32 exec_lo, 0x1010101
  s_mov_b32 exec_hi, 0x1010101
  ds_write_b16 v60, v58 offset:34048
  ds_write_b16_d16_hi v60, v58 offset:34050
  ds_write_b16 v60, v59 offset:34052
  s_mov_b64 exec, -1
  s_waitcnt lgkmcnt(0)
  s_barrier
  ds_read_b128 v[28:31], v54 offset:34048
  ds_read_b128 v[32:35], v54 offset:34176
  ds_read_b128 v[36:39], v54 offset:34304
  s_waitcnt lgkmcnt(0)
  v_dot2c_f32_bf16 v40, v64, v28
  v_dot2c_f32_bf16 v41, v76, v28
  v_dot2c_f32_bf16 v40, v65, v29
  v_dot2c_f32_bf16 v41, v77, v29
  v_dot2c_f32_bf16 v40, v66, v30
  v_dot2c_f32_bf16 v41, v78, v30
  v_dot2c_f32_bf16 v40, v67, v31
  v_dot2c_f32_bf16 v41, v79, v31
  v_dot2c_f32_bf16 v40, v68, v32
  v_dot2c_f32_bf16 v41, v80, v32
  v_dot2c_f32_bf16 v40, v69, v33
  v_dot2c_f32_bf16 v41, v81, v33
  v_dot2c_f32_bf16 v40, v70, v34
  v_dot2c_f32_bf16 v41, v82, v34
  v_dot2c_f32_bf16 v40, v71, v35
  v_dot2c_f32_bf16 v41, v83, v35
  v_dot2c_f32_bf16 v40, v72, v36
  v_dot2c_f32_bf16 v41, v84, v36
  v_dot2c_f32_bf16 v40, v73, v37
  v_dot2c_f32_bf16 v41, v85, v37
  v_dot2c_f32_bf16 v40, v74, v38
  v_dot2c_f32_bf16 v41, v86, v38
  v_dot2c_f32_bf16 v40, v75, v39
  v_dot2c_f32_bf16 v41, v87, v39
  s_nop 1
  v_add_f32_dpp v40, v40, v40 quad_perm:[1,0,3,2] row_mask:0xf bank_mask:0xf
  v_add_f32_dpp v41, v41, v41 quad_perm:[1,0,3,2] row_mask:0xf bank_mask:0xf
  s_nop 0
  v_add_f32_dpp v40, v40, v40 quad_perm:[2,3,0,1] row_mask:0xf bank_mask:0xf
  v_add_f32_dpp v41, v41, v41 quad_perm:[2,3,0,1] row_mask:0xf bank_mask:0xf
  s_nop 0
  v_add_f32_dpp v40, v40, v40 row_half_mirror row_mask:0xf bank_mask:0xf
  v_add_f32_dpp v41, v41, v41 row_half_mirror row_mask:0xf bank_mask:0xf
  v_cvt_pk_bf16_f32 v40, v40, v41
  v_and_b32 v41, 0xffff0000, v40
  v_lshlrev_b32 v40, 16, v40
  v_mul_f32 v40, 0x3d93cd3a, v40
  v_mul_f32 v41, 0x3d93cd3a, v41
  v_cvt_pk_bf16_f32 v40, v40, v41
  v_and_b32 v41, 0xffff0000, v40
  v_lshlrev_b32 v40, 16, v40
  s_waitcnt vmcnt(0)
  buffer_load_dwordx4 v[148:151], v1, s[36:39], s16 offen offset:0 nt
  buffer_load_dwordx4 v[152:155], v1, s[36:39], s16 offen offset:128 nt
  buffer_load_dwordx4 v[156:159], v1, s[36:39], s16 offen offset:256 nt
  v_dot2c_f32_bf16 v42, v88, v28
  v_dot2c_f32_bf16 v43, v100, v28
  v_dot2c_f32_bf16 v42, v89, v29
  v_dot2c_f32_bf16 v43, v101, v29
  v_dot2c_f32_bf16 v42, v90, v30
  v_dot2c_f32_bf16 v43, v102, v30
  v_dot2c_f32_bf16 v42, v91, v31
  v_dot2c_f32_bf16 v43, v103, v31
  v_dot2c_f32_bf16 v42, v92, v32
  v_dot2c_f32_bf16 v43, v104, v32
  v_dot2c_f32_bf16 v42, v93, v33
  v_dot2c_f32_bf16 v43, v105, v33
  v_dot2c_f32_bf16 v42, v94, v34
  v_dot2c_f32_bf16 v43, v106, v34
  v_dot2c_f32_bf16 v42, v95, v35
  v_dot2c_f32_bf16 v43, v107, v35
  v_dot2c_f32_bf16 v42, v96, v36
  v_dot2c_f32_bf16 v43, v108, v36
  v_dot2c_f32_bf16 v42, v97, v37
  v_dot2c_f32_bf16 v43, v109, v37
  v_dot2c_f32_bf16 v42, v98, v38
  v_dot2c_f32_bf16 v43, v110, v38
  v_dot2c_f32_bf16 v42, v99, v39
  v_dot2c_f32_bf16 v43, v111, v39
  s_nop 1
  v_add_f32_dpp v42, v42, v42 quad_perm:[1,0,3,2] row_mask:0xf bank_mask:0xf
  v_add_f32_dpp v43, v43, v43 quad_perm:[1,0,3,2] row_mask:0xf bank_mask:0xf
  s_nop 0
  v_add_f32_dpp v42, v42, v42 quad_perm:[2,3,0,1] row_mask:0xf bank_mask:0xf
  v_add_f32_dpp v43, v43, v43 quad_perm:[2,3,0,1] row_mask:0xf bank_mask:0xf
  s_nop 0
  v_add_f32_dpp v42, v42, v42 row_half_mirror row_mask:0xf bank_mask:0xf
  v_add_f32_dpp v43, v43, v43 row_half_mirror row_mask:0xf bank_mask:0xf
  v_cvt_pk_bf16_f32 v42, v42, v43
  v_and_b32 v43, 0xffff0000, v42
  v_lshlrev_b32 v42, 16, v42
  v_mul_f32 v42, 0x3d93cd3a, v42
  v_mul_f32 v43, 0x3d93cd3a, v43
  v_cvt_pk_bf16_f32 v42, v42, v43
  v_and_b32 v43, 0xffff0000, v42
  v_lshlrev_b32 v42, 16, v42
  v_dot2c_f32_bf16 v44, v112, v28
  v_dot2c_f32_bf16 v45, v124, v28
  v_dot2c_f32_bf16 v44, v113, v29
  v_dot2c_f32_bf16 v45, v125, v29
  v_dot2c_f32_bf16 v44, v114, v30
  v_dot2c_f32_bf16 v45, v126, v30
  v_dot2c_f32_bf16 v44, v115, v31
  v_dot2c_f32_bf16 v45, v127, v31
  v_dot2c_f32_bf16 v44, v116, v32
  v_dot2c_f32_bf16 v45, v128, v32
  v_dot2c_f32_bf16 v44, v117, v33
  v_dot2c_f32_bf16 v45, v129, v33
  v_dot2c_f32_bf16 v44, v118, v34
  v_dot2c_f32_bf16 v45, v130, v34
  v_dot2c_f32_bf16 v44, v119, v35
  v_dot2c_f32_bf16 v45, v131, v35
  v_dot2c_f32_bf16 v44, v120, v36
  v_dot2c_f32_bf16 v45, v132, v36
  v_dot2c_f32_bf16 v44, v121, v37
  v_dot2c_f32_bf16 v45, v133, v37
  v_dot2c_f32_bf16 v44, v122, v38
  v_dot2c_f32_bf16 v45, v134, v38
  v_dot2c_f32_bf16 v44, v123, v39
  v_dot2c_f32_bf16 v45, v135, v39
  s_nop 1
  v_add_f32_dpp v44, v44, v44 quad_perm:[1,0,3,2] row_mask:0xf bank_mask:0xf
  v_add_f32_dpp v45, v45, v45 quad_perm:[1,0,3,2] row_mask:0xf bank_mask:0xf
  s_nop 0
  v_add_f32_dpp v44, v44, v44 quad_perm:[2,3,0,1] row_mask:0xf bank_mask:0xf
  v_add_f32_dpp v45, v45, v45 quad_perm:[2,3,0,1] row_mask:0xf bank_mask:0xf
  s_nop 0
  v_add_f32_dpp v44, v44, v44 row_half_mirror row_mask:0xf bank_mask:0xf
  v_add_f32_dpp v45, v45, v45 row_half_mirror row_mask:0xf bank_mask:0xf
  v_cvt_pk_bf16_f32 v44, v44, v45
  v_and_b32 v45, 0xffff0000, v44
  v_lshlrev_b32 v44, 16, v44
  v_mul_f32 v44, 0x3d93cd3a, v44
  v_mul_f32 v45, 0x3d93cd3a, v45
  v_cvt_pk_bf16_f32 v44, v44, v45
  v_and_b32 v45, 0xffff0000, v44
  v_lshlrev_b32 v44, 16, v44
  s_waitcnt vmcnt(0)
  buffer_load_dwordx4 v[160:163], v1, s[40:43], s70 offen offset:0 nt
  buffer_load_dwordx4 v[164:167], v1, s[40:43], s70 offen offset:128 nt
  buffer_load_dwordx4 v[168:171], v1, s[40:43], s70 offen offset:256 nt
  v_dot2c_f32_bf16 v46, v136, v28
  v_dot2c_f32_bf16 v47, v148, v28
  v_dot2c_f32_bf16 v46, v137, v29
  v_dot2c_f32_bf16 v47, v149, v29
  v_dot2c_f32_bf16 v46, v138, v30
  v_dot2c_f32_bf16 v47, v150, v30
  v_dot2c_f32_bf16 v46, v139, v31
  v_dot2c_f32_bf16 v47, v151, v31
  v_dot2c_f32_bf16 v46, v140, v32
  v_dot2c_f32_bf16 v47, v152, v32
  v_dot2c_f32_bf16 v46, v141, v33
  v_dot2c_f32_bf16 v47, v153, v33
  v_dot2c_f32_bf16 v46, v142, v34
  v_dot2c_f32_bf16 v47, v154, v34
  v_dot2c_f32_bf16 v46, v143, v35
  v_dot2c_f32_bf16 v47, v155, v35
  v_dot2c_f32_bf16 v46, v144, v36
  v_dot2c_f32_bf16 v47, v156, v36
  v_dot2c_f32_bf16 v46, v145, v37
  v_dot2c_f32_bf16 v47, v157, v37
  v_dot2c_f32_bf16 v46, v146, v38
  v_dot2c_f32_bf16 v47, v158, v38
  v_dot2c_f32_bf16 v46, v147, v39
  v_dot2c_f32_bf16 v47, v159, v39
  s_nop 1
  v_add_f32_dpp v46, v46, v46 quad_perm:[1,0,3,2] row_mask:0xf bank_mask:0xf
  v_add_f32_dpp v47, v47, v47 quad_perm:[1,0,3,2] row_mask:0xf bank_mask:0xf
  s_nop 0
  v_add_f32_dpp v46, v46, v46 quad_perm:[2,3,0,1] row_mask:0xf bank_mask:0xf
  v_add_f32_dpp v47, v47, v47 quad_perm:[2,3,0,1] row_mask:0xf bank_mask:0xf
  s_nop 0
  v_add_f32_dpp v46, v46, v46 row_half_mirror row_mask:0xf bank_mask:0xf
  v_add_f32_dpp v47, v47, v47 row_half_mirror row_mask:0xf bank_mask:0xf
  v_cvt_pk_bf16_f32 v46, v46, v47
  v_and_b32 v47, 0xffff0000, v46
  v_lshlrev_b32 v46, 16, v46
  v_mul_f32 v46, 0x3d93cd3a, v46
  v_mul_f32 v47, 0x3d93cd3a, v47
  v_cvt_pk_bf16_f32 v46, v46, v47
  v_and_b32 v47, 0xffff0000, v46
  v_lshlrev_b32 v46, 16, v46
  v_max3_f32 v58, v40, v41, v42
  v_max3_f32 v59, v43, v44, v45
  v_max3_f32 v58, v58, v46, v47
  v_max_f32 v58, v58, v59
  s_nop 1
  v_permlane32_swap_b32 v58, v59
  v_max_f32 v58, v58, v59
  s_nop 1
  v_permlane16_swap_b32 v58, v59
  v_max_f32 v58, v58, v59
  s_nop 1
  v_max_f32_dpp v58, v58, v58 row_ror:8 row_mask:0xf bank_mask:0xf
  v_mul_f32 v48, s80, v58
  s_lshl_b32 s35, s32, 3
  v_readfirstlane_b32 s34, v48
  v_mov_b32 v62, s35
  v_lshrrev_b32 v63, 1, v54
  v_mov_b32 v57, s34
  v_fma_f32 v40, v40, s80, -v57
  v_fma_f32 v41, v41, s80, -v57
  v_fma_f32 v42, v42, s80, -v57
  v_fma_f32 v43, v43, s80, -v57
  v_fma_f32 v44, v44, s80, -v57
  v_fma_f32 v45, v45, s80, -v57
  v_fma_f32 v46, v46, s80, -v57
  v_fma_f32 v47, v47, s80, -v57
  v_exp_f32 v40, v40
  v_exp_f32 v41, v41
  v_exp_f32 v42, v42
  v_exp_f32 v43, v43
  v_exp_f32 v44, v44
  v_exp_f32 v45, v45
  v_exp_f32 v46, v46
  v_exp_f32 v47, v47
  v_add_f32 v58, v40, v41
  v_add_f32 v59, v42, v43
  v_add_f32 v60, v44, v45
  v_add_f32 v61, v46, v47
  v_add_f32 v58, v58, v59
  v_add_f32 v60, v60, v61
  v_add_f32 v49, v58, v60
  s_nop 1
  v_permlane32_swap_b32 v49, v59
  v_add_f32 v49, v49, v59
  s_nop 1
  v_permlane16_swap_b32 v49, v59
  v_add_f32 v49, v49, v59
  s_nop 1
  v_add_f32_dpp v49, v49, v49 row_ror:8 row_mask:0xf bank_mask:0xf
  s_mov_b64 exec, 0x1
  ds_write_b64 v62, v[48:49] offset:34432
  s_mov_b64 exec, -1
  s_waitcnt lgkmcnt(0)
  s_barrier
  ds_read_b64 v[58:59], v63 offset:34432
  v_mov_b32 v51, s33
  s_cmp_eq_u32 s32, 0
  s_cselect_b32 s34, 0, 16777216
  v_add_u32 v62, s34, v54
  s_waitcnt lgkmcnt(0)
  v_mov_b32 v48, v58
  s_nop 1
  v_max_f32_dpp v48, v48, v48 quad_perm:[1,0,3,2] row_mask:0xf bank_mask:0xf
  s_nop 1
  v_max_f32_dpp v48, v48, v48 quad_perm:[2,3,0,1] row_mask:0xf bank_mask:0xf
  s_nop 1
  v_max_f32_dpp v48, v48, v48 row_half_mirror row_mask:0xf bank_mask:0xf
  v_sub_f32 v58, v58, v48
  v_sub_f32 v57, v57, v48
  v_exp_f32 v58, v58
  v_exp_f32 v57, v57
  v_mul_f32 v49, v58, v59
  v_mul_f32 v40, v40, v57
  v_mul_f32 v41, v41, v57
  v_add_f32_dpp v49, v49, v49 quad_perm:[1,0,3,2] row_mask:0xf bank_mask:0xf
  v_mul_f32 v42, v42, v57
  v_mul_f32 v43, v43, v57
  v_add_f32_dpp v49, v49, v49 quad_perm:[2,3,0,1] row_mask:0xf bank_mask:0xf
  v_mul_f32 v44, v44, v57
  v_mul_f32 v45, v45, v57
  v_add_f32_dpp v49, v49, v49 row_half_mirror row_mask:0xf bank_mask:0xf
  v_mul_f32 v46, v46, v57
  v_mul_f32 v47, v47, v57
  s_mov_b64 exec, 0xff
  s_cmp_lg_u32 s3, 0
  s_cbranch_scc0 L_A_pubml_far
  buffer_store_dwordx4 v[48:51], v62, s[56:59], s73 offen
L_A_pubml_done:
  s_mov_b64 exec, -1
  v_cvt_pk_bf16_f32 v40, v40, v40
  v_cvt_pk_bf16_f32 v41, v41, v41
  v_cvt_pk_bf16_f32 v42, v42, v42
  v_cvt_pk_bf16_f32 v43, v43, v43
  v_cvt_pk_bf16_f32 v44, v44, v44
  v_cvt_pk_bf16_f32 v45, v45, v45
  v_cvt_pk_bf16_f32 v46, v46, v46
  v_cvt_pk_bf16_f32 v47, v47, v47
  v_and_b32 v8, v40, v4
  v_and_b32 v9, v40, v5
  v_and_b32 v10, v40, v6
  v_and_b32 v11, v40, v7
  s_waitcnt vmcnt(1)
  buffer_load_dwordx4 v[172:175], v1, s[40:43], s24 offen offset:0 nt
  buffer_load_dwordx4 v[176:179], v1, s[40:43], s24 offen offset:128 nt
  buffer_load_dwordx4 v[180:183], v1, s[40:43], s24 offen offset:256 nt
  v_bfe_u32 v59, v0, 3, 3
  v_bfe_u32 v58, v0, 4, 1
  v_lshlrev_b32 v58, 4, v58
  v_lshl_add_u32 v58, v54, 1, v58
  v_bfe_u32 v60, v0, 5, 1
  s_lshr_b32 s34, s32, 1
  s_mul_i32 s34, s34, 2112
  s_and_b32 s35, s32, 1
  s_mul_i32 s35, s35, 1024
  s_add_u32 s34, s34, s35
  s_add_u32 s34, s34, 12544
  v_mul_u32_u24 v89, 512, v60
  v_add3_u32 v89, v89, v58, s34
  v_and_b32 v61, 1, v0
  v_lshl_add_u32 v61, v60, 1, v61
  v_mul_u32_u24 v90, 2112, v61
  v_and_b32 v61, 30, v0
  s_lshl_b32 s34, s32, 6
  s_add_u32 s34, s34, 12544
  v_lshl_add_u32 v90, v61, 1, v90
  v_add_u32 v90, s34, v90
  v_lshl_add_u32 v149, v60, 8, v61
  v_lshrrev_b32 v61, 1, v54
  v_lshl_add_u32 v148, v59, 8, v61
  v_mul_u32_u24 v61, 7168, v60
  v_add_u32 v148, v148, v61
  v_mov_b32 v152, 0
  v_mov_b32 v153, 0x3ff00000
  v_lshlrev_b32 v91, 7, v59
  s_mul_i32 s34, s30, 192
  s_mul_i32 s35, s32, 24
  s_add_u32 s34, s34, s35
  s_mul_i32 s34, s34, 1280
  s_lshl_b32 s35, s31, 8
  s_add_u32 s34, s34, s35
  s_lshl3_add_u32 s78, s31, s32
  s_mov_b32 s22, -1
  s_mov_b32 s23, 0
  s_movk_i32 s68, 15360
  v_bfe_u32 v58, v0, 4, 2
  v_mul_u32_u24 v88, 3840, v58
  v_and_b32 v58, 15, v0
  v_lshl_add_u32 v88, v58, 4, v88
  v_add_u32 v88, s34, v88
  v_bfe_u32 v60, v0, 3, 1
  v_lshl_add_u32 v89, v60, 8, v89
  v_and_b32 v60, 3, v0
  v_cmp_eq_u32 vcc, 3, v60
  v_mov_b32 v61, 0xffff
  v_mov_b32 v62, 0xffff0000
  v_cndmask_b32 v61, v61, v62, vcc
  v_cndmask_b32 v60, v60, 0, vcc
  v_or_b32 v60, 12, v60
  v_mul_u32_u24 v120, 0x1111, v60
  v_bfe_u32 v58, v0, 2, 2
  v_cmp_eq_u32 vcc, 0, v58
  v_mov_b32 v116, 0
  s_nop 0
  v_cndmask_b32 v112, 0, v61, vcc
  v_cmp_eq_u32 vcc, 1, v58
  v_mov_b32 v117, 0
  s_nop 0
  v_cndmask_b32 v113, 0, v61, vcc
  v_cmp_eq_u32 vcc, 2, v58
  v_mov_b32 v118, 0
  s_nop 0
  v_cndmask_b32 v114, 0, v61, vcc
  v_cmp_eq_u32 vcc, 3, v58
  v_mov_b32 v119, 0
  s_nop 0
  v_cndmask_b32 v115, 0, v61, vcc
  s_lshl_b32 s77, s78, 10
  s_add_u32 s77, s77, 786432
  s_lshl_b32 s78, s78, 5
  s_add_u32 s5, s33, 16
  v_mfma_f32_16x16x32_bf16 v[16:19], v[8:11], v[160:163], 0
  v_and_b32 v12, v41, v4
  v_and_b32 v13, v41, v5
  v_and_b32 v14, v41, v6
  v_and_b32 v15, v41, v7
  v_mfma_f32_16x16x32_bf16 v[20:23], v[8:11], v[164:167], 0
  v_mfma_f32_16x16x32_bf16 v[24:27], v[8:11], v[168:171], 0
  s_waitcnt vmcnt(0)
  buffer_load_dwordx4 v[184:187], v1, s[40:43], s25 offen offset:0 nt
  buffer_load_dwordx4 v[188:191], v1, s[40:43], s25 offen offset:128 nt
  buffer_load_dwordx4 v[192:195], v1, s[40:43], s25 offen offset:256 nt
  v_mfma_f32_16x16x32_bf16 v[16:19], v[12:15], v[172:175], v[16:19]
  v_and_b32 v8, v42, v4
  v_and_b32 v9, v42, v5
  v_and_b32 v10, v42, v6
  v_and_b32 v11, v42, v7
  v_mfma_f32_16x16x32_bf16 v[20:23], v[12:15], v[176:179], v[20:23]
  v_mfma_f32_16x16x32_bf16 v[24:27], v[12:15], v[180:183], v[24:27]
  s_waitcnt vmcnt(0)
  buffer_load_dwordx4 v[196:199], v1, s[40:43], s26 offen offset:0 nt
  buffer_load_dwordx4 v[200:203], v1, s[40:43], s26 offen offset:128 nt
  buffer_load_dwordx4 v[204:207], v1, s[40:43], s26 offen offset:256 nt
  v_mfma_f32_16x16x32_bf16 v[16:19], v[8:11], v[184:187], v[16:19]
  v_and_b32 v12, v43, v4
  v_and_b32 v13, v43, v5
  v_and_b32 v14, v43, v6
  v_and_b32 v15, v43, v7
  v_mfma_f32_16x16x32_bf16 v[20:23], v[8:11], v[188:191], v[20:23]
  v_mfma_f32_16x16x32_bf16 v[24:27], v[8:11], v[192:195], v[24:27]
  s_waitcnt vmcnt(0)
  buffer_load_dwordx4 v[208:211], v1, s[40:43], s27 offen offset:0 nt
  buffer_load_dwordx4 v[212:215], v1, s[40:43], s27 offen offset:128 nt
  buffer_load_dwordx4 v[216:219], v1, s[40:43], s27 offen offset:256 nt
  buffer_load_dwordx4 v[48:51], v91, s[56:59], s74 offen sc1
  v_mfma_f32_16x16x32_bf16 v[16:19], v[12:15], v[196:199], v[16:19]
  v_and_b32 v8, v44, v4
  v_and_b32 v9, v44, v5
  v_and_b32 v10, v44, v6
  v_and_b32 v11, v44, v7
  v_mfma_f32_16x16x32_bf16 v[20:23], v[12:15], v[200:203], v[20:23]
  v_mfma_f32_16x16x32_bf16 v[24:27], v[12:15], v[204:207], v[24:27]
  s_waitcnt vmcnt(1)
  buffer_load_dwordx4 v[220:223], v1, s[40:43], s28 offen offset:0 nt
  buffer_load_dwordx4 v[224:227], v1, s[40:43], s28 offen offset:128 nt
  buffer_load_dwordx4 v[228:231], v1, s[40:43], s28 offen offset:256 nt
  v_mfma_f32_16x16x32_bf16 v[16:19], v[8:11], v[208:211], v[16:19]
  v_and_b32 v12, v45, v4
  v_and_b32 v13, v45, v5
  v_and_b32 v14, v45, v6
  v_and_b32 v15, v45, v7
  v_mfma_f32_16x16x32_bf16 v[20:23], v[8:11], v[212:215], v[20:23]
  v_mfma_f32_16x16x32_bf16 v[24:27], v[8:11], v[216:219], v[24:27]
  s_waitcnt vmcnt(0)
  buffer_load_dwordx4 v[232:235], v1, s[40:43], s29 offen offset:0 nt
  buffer_load_dwordx4 v[236:239], v1, s[40:43], s29 offen offset:128 nt
  buffer_load_dwordx4 v[240:243], v1, s[40:43], s29 offen offset:256 nt
L_A_mlpoll_chk:
  v_cmp_ne_u32 vcc, s33, v51
  s_cbranch_vccnz L_A_mlpoll_retry
  s_or_b32 s34, s31, s32
  s_cbranch_scc1 L_A_nocount
  s_mov_b32 s12, 1
  s_atomic_add s12, s[10:11], 0 glc
L_A_nocount:
  v_mov_b32 v58, v48
  v_readlane_b32 s9, v50, 40
  s_nop 0
  v_permlane32_swap_b32 v58, v59
  v_max_f32 v58, v58, v59
  s_nop 1
  v_permlane16_swap_b32 v58, v59
  v_max_f32 v58, v58, v59
  s_nop 1
  v_max_f32_dpp v58, v58, v58 row_ror:8 row_mask:0xf bank_mask:0xf
  s_nop 0
  v_readfirstlane_b32 s34, v58
  s_nop 1
  v_subrev_f32 v57, s34, v48
  v_exp_f32 v57, v57
  s_nop 0
  v_mul_f32 v58, v57, v49
  s_nop 1
  v_permlane32_swap_b32 v58, v59
  v_add_f32 v58, v58, v59
  s_nop 1
  v_permlane16_swap_b32 v58, v59
  v_add_f32 v58, v58, v59
  s_nop 1
  v_add_f32_dpp v58, v58, v58 row_ror:8 row_mask:0xf bank_mask:0xf
  v_rcp_f32 v58, v58
  s_nop 0
  v_readfirstlane_b32 s34, v58
  s_nop 1
  v_mul_f32 v57, s34, v57
  v_mfma_f32_16x16x32_bf16 v[16:19], v[12:15], v[220:223], v[16:19]
  v_and_b32 v8, v46, v4
  v_and_b32 v9, v46, v5
  v_and_b32 v10, v46, v6
  v_and_b32 v11, v46, v7
  v_mfma_f32_16x16x32_bf16 v[20:23], v[12:15], v[224:227], v[20:23]
  v_mfma_f32_16x16x32_bf16 v[24:27], v[12:15], v[228:231], v[24:27]
  s_waitcnt vmcnt(0)
  buffer_load_dwordx4 v[244:247], v1, s[40:43], s16 offen offset:0 nt
  buffer_load_dwordx4 v[248:251], v1, s[40:43], s16 offen offset:128 nt
  buffer_load_dwordx4 v[252:255], v1, s[40:43], s16 offen offset:256 nt
  v_mfma_f32_16x16x32_bf16 v[16:19], v[8:11], v[232:235], v[16:19]
  v_and_b32 v12, v47, v4
  v_and_b32 v13, v47, v5
  v_and_b32 v14, v47, v6
  v_and_b32 v15, v47, v7
  v_mfma_f32_16x16x32_bf16 v[20:23], v[8:11], v[236:239], v[20:23]
  v_mfma_f32_16x16x32_bf16 v[24:27], v[8:11], v[240:243], v[24:27]
  s_waitcnt vmcnt(0)
  buffer_load_dwordx4 v[64:67], v88, s[48:51], 0 offen offset:0 nt
  buffer_load_dwordx4 v[68:71], v88, s[48:51], s68 offen offset:0 nt
  buffer_load_dwordx4 v[72:75], v88, s[48:51], 0 offen offset:1280 nt
  v_mfma_f32_16x16x32_bf16 v[16:19], v[12:15], v[244:247], v[16:19]
  v_mfma_f32_16x16x32_bf16 v[20:23], v[12:15], v[248:251], v[20:23]
  v_mfma_f32_16x16x32_bf16 v[24:27], v[12:15], v[252:255], v[24:27]
  buffer_load_dwordx4 v[76:79], v88, s[48:51], s68 offen offset:1280 nt
  s_mov_b64 exec, s[20:21]
  s_nop 3
  ds_write_b128 v52, v[16:19] offset:0
  ds_write_b128 v52, v[20:23] offset:256
  ds_write_b128 v52, v[24:27] offset:512
  s_mov_b64 exec, -1
  s_waitcnt lgkmcnt(0)
  s_barrier
  ds_read2_b32 v[58:59], v53 offset0:0 offset1:192
  ds_read2_b32 v[60:61], v53 offset0:1 offset1:193
  ds_read2_b32 v[62:63], v53 offset0:2 offset1:194
  v_mov_b32 v51, s5
  s_cmp_lg_u32 s3, 0
  s_waitcnt lgkmcnt(2)
  v_add_f32 v48, v58, v59
  s_waitcnt lgkmcnt(1)
  v_add_f32 v49, v60, v61
  s_waitcnt lgkmcnt(0)
  v_add_f32 v50, v62, v63
  v_permlane32_swap_b32 v48, v58
  v_permlane32_swap_b32 v49, v59
  v_permlane32_swap_b32 v50, v60
  v_add_f32 v48, v48, v58
  v_add_f32 v49, v49, v59
  v_add_f32 v50, v50, v60
  v_permlane16_swap_b32 v48, v58
  v_permlane16_swap_b32 v49, v59
  v_permlane16_swap_b32 v50, v60
  v_add_f32 v48, v48, v58
  v_add_f32 v49, v49, v59
  v_add_f32 v50, v50, v60
  v_add_f32_dpp v48, v48, v48 row_ror:8 row_mask:0xf bank_mask:0xf
  v_add_f32_dpp v49, v49, v49 row_ror:8 row_mask:0xf bank_mask:0xf
  v_add_f32_dpp v50, v50, v50 row_ror:8 row_mask:0xf bank_mask:0xf
  s_mov_b64 exec, 0xff
  s_cbranch_scc0 L_A_pubo_far
  buffer_store_dwordx4 v[48:51], v54, s[56:59], s75 offen
L_A_pubo_done:
  s_mov_b64 exec, -1
  buffer_load_dwordx4 v[80:83], v88, s[48:51], 0 offen offset:2560 nt
  buffer_load_dwordx4 v[84:87], v88, s[48:51], s68 offen offset:2560 nt
  s_and_b32 s12, s12, 31
  s_cmp_eq_u32 s12, 31
  s_cbranch_scc1 L_A_retire
L_A_retired:
  s_waitcnt vmcnt(1)
L_A_opoll:
  buffer_load_dwordx4 v[104:107], v55, s[56:59], s76 offen sc1
  s_add_u32 s79, s79, 1
  s_cmp_gt_u32 s79, 8388608
  s_cbranch_scc1 L_A_exit
  s_waitcnt vmcnt(0)
  v_cmp_ne_u32 vcc, s5, v107
  v_mul_f32 v104, v104, v57
  v_mul_f32 v105, v105, v57
  v_mul_f32 v106, v106, v57
  s_cbranch_vccnz L_A_opoll
  ds_bpermute_b32 v58, v56, v104
  ds_bpermute_b32 v59, v56, v105
  ds_bpermute_b32 v60, v56, v106
  s_waitcnt lgkmcnt(0)
  v_add_f32_dpp v58, v58, v58 quad_perm:[1,0,3,2] row_mask:0xf bank_mask:0xf
  v_add_f32_dpp v59, v59, v59 quad_perm:[1,0,3,2] row_mask:0xf bank_mask:0xf
  v_add_f32_dpp v60, v60, v60 quad_perm:[1,0,3,2] row_mask:0xf bank_mask:0xf
  v_add_f32_dpp v58, v58, v58 quad_perm:[2,3,0,1] row_mask:0xf bank_mask:0xf
  v_add_f32_dpp v59, v59, v59 quad_perm:[2,3,0,1] row_mask:0xf bank_mask:0xf
  v_add_f32_dpp v60, v60, v60 quad_perm:[2,3,0,1] row_mask:0xf bank_mask:0xf
  v_add_f32_dpp v58, v58, v58 row_half_mirror row_mask:0xf bank_mask:0xf
  v_add_f32_dpp v59, v59, v59 row_half_mirror row_mask:0xf bank_mask:0xf
  v_add_f32_dpp v60, v60, v60 row_half_mirror row_mask:0xf bank_mask:0xf
  v_cvt_pk_bf16_f32 v58, v58, v58
  v_cvt_pk_bf16_f32 v59, v59, v59
  v_cvt_pk_bf16_f32 v60, v60, v60
  v_and_b32 v92, v58, v112
  v_and_b32 v93, v58, v113
  v_and_b32 v94, v58, v114
  v_and_b32 v95, v58, v115
  v_and_b32 v96, v59, v112
  v_and_b32 v97, v59, v113
  v_and_b32 v98, v59, v114
  v_and_b32 v99, v59, v115
  v_smfmac_f32_16x16x64_bf16 v[116:119], v[92:95], v[64:71], v120
  v_and_b32 v100, v60, v112
  v_and_b32 v101, v60, v113
  v_and_b32 v102, v60, v114
  v_and_b32 v103, v60, v115
  v_smfmac_f32_16x16x64_bf16 v[116:119], v[96:99], v[72:79], v120
  s_nop 0
  v_smfmac_f32_16x16x64_bf16 v[116:119], v[100:103], v[80:87], v120
  s_nop 7
  ds_write_b128 v89, v[116:119]
  s_waitcnt lgkmcnt(0)
  s_barrier
  ds_read2st64_b32 v[92:93], v90 offset0:0 offset1:2
  ds_read2st64_b32 v[94:95], v90 offset0:4 offset1:6
  s_waitcnt lgkmcnt(1)
  v_add_f32 v92, v92, v93
  s_waitcnt lgkmcnt(0)
  v_add_f32 v94, v94, v95
  v_add_f32 v92, v92, v94
  s_nop 1
  v_permlane32_swap_b32 v92, v93
  v_add_f32 v92, v92, v93
  s_nop 1
  v_add_f32_dpp v92, v92, v92 quad_perm:[1,0,3,2] row_mask:0xf bank_mask:0xf
  s_mov_b64 exec, 0x55555555
  v_mul_f32 v92, s9, v92
  v_cvt_f64_f32 v[152:153], v92
  s_mov_b64 exec, s[22:23]
L_A_acc:
  buffer_atomic_add_f64 v[152:153], v148, s[56:59], s77 offen sc0 sc1
  v_cvt_f64_f32 v[150:151], v92
  s_mov_b32 s4, 0xaaaaaaaa
  s_mov_b32 s5, 0xaaaaaaaa
  s_add_u32 s79, s79, 1
  s_waitcnt vmcnt(0)
  v_add_f64 v[58:59], v[152:153], v[150:151]
  v_subrev_u32 v60, s7, v152
  v_cmp_ne_u32 s[18:19], s6, v153
  v_cvt_f32_f64 v58, v[58:59]
  v_cmp_lt_u32 s[14:15], 55, v60
  v_cmp_eq_u32 vcc, 55, v60
  v_cvt_pk_bf16_f32 v58, v58, v58
  s_andn2_b64 vcc, vcc, s[18:19]
  s_and_b64 vcc, vcc, s[4:5]
  s_lshr_b64 exec, vcc, 1
  s_cbranch_execz L_A_notlast
  buffer_store_short v58, v149, s[60:63], s78 offen
L_A_notlast:
  s_or_b64 s[18:19], s[18:19], s[14:15]
  s_and_b64 s[18:19], s[18:19], s[4:5]
  s_cbranch_scc1 L_A_again
  s_endpgm
L_A_qpoll_remote:
  s_cmp_lg_u32 s17, 0
  s_cbranch_scc1 L_A_qpoll_rm_np
  s_mov_b32 s17, 1
  s_mov_b64 s[18:19], exec
  s_mov_b64 exec, 0xff
  s_lshl_b32 s34, s32, 7
  v_add_u32 v62, s34, v54
  ds_read_b128 v[58:61], v62 offset:34560
  s_waitcnt lgkmcnt(0)
  buffer_store_dwordx4 v[58:61], v54, s[56:59], s71 offen sc1
  s_waitcnt vmcnt(0)
  s_mov_b64 exec, s[18:19]
L_A_qpoll_rm_np:
  s_mov_b32 s3, 0
  s_branch L_A_qpoll_back
L_A_qpoll_retry:
  s_cmp_lg_u32 s17, 0
  s_cbranch_scc1 L_A_qpoll_rt_np
  s_mov_b32 s17, 1
  s_mov_b64 s[18:19], exec
  s_mov_b64 exec, 0xff
  s_lshl_b32 s34, s32, 7
  v_add_u32 v62, s34, v54
  ds_read_b128 v[58:61], v62 offset:34560
  s_waitcnt lgkmcnt(0)
  buffer_store_dwordx4 v[58:61], v54, s[56:59], s71 offen sc1
  s_waitcnt vmcnt(0)
  s_mov_b64 exec, s[18:19]
L_A_qpoll_rt_np:
  buffer_load_dwordx4 v[48:51], v55, s[56:59], s72 offen sc1
  s_add_u32 s79, s79, 1
  s_cmp_gt_u32 s79, 8388608
  s_cbranch_scc1 L_A_exit
  s_waitcnt vmcnt(0)
  s_branch L_A_qpoll_chk
L_A_pubml_far:
  buffer_store_dwordx4 v[48:51], v62, s[56:59], s73 offen sc1
  s_branch L_A_pubml_done
L_A_mlpoll_retry:
  s_cmp_lg_u32 s17, 0
  s_cbranch_scc1 L_A_mlpoll_rt_np
  s_mov_b32 s17, 1
  s_mov_b64 s[18:19], exec
  s_mov_b64 exec, 0xff
  s_lshl_b32 s34, s32, 7
  v_add_u32 v62, s34, v54
  ds_read_b128 v[58:61], v62 offset:34560
  s_waitcnt lgkmcnt(0)
  buffer_store_dwordx4 v[58:61], v54, s[56:59], s71 offen sc1
  s_waitcnt vmcnt(0)
  s_mov_b64 exec, s[18:19]
L_A_mlpoll_rt_np:
  buffer_load_dwordx4 v[48:51], v91, s[56:59], s74 offen sc1
  s_add_u32 s79, s79, 1
  s_cmp_gt_u32 s79, 8388608
  s_cbranch_scc1 L_A_exit
  s_waitcnt vmcnt(0)
  s_branch L_A_mlpoll_chk
L_A_pubo_far:
  buffer_store_dwordx4 v[48:51], v54, s[56:59], s75 offen sc1
  s_branch L_A_pubo_done
L_A_retire:
  s_mov_b64 exec, 1
  v_mov_b32 v62, s33
  buffer_store_dword v62, v54, s[56:59], 0 offen sc1
  s_mov_b64 exec, -1
  s_branch L_A_retired
L_A_again:
  s_mov_b64 exec, s[18:19]
  v_mov_b32 v152, 0
  v_mov_b32 v153, 0x3ff00000
  s_lshr_b64 exec, s[18:19], 1
  v_cvt_f64_f32 v[152:153], v92
  s_or_b64 exec, exec, s[18:19]
  s_cmp_gt_u32 s79, 8388608
  s_cbranch_scc0 L_A_acc
L_A_exit:
  s_endpgm
L_F:
  s_cmp_ge_u32 s2, 256
  s_cbranch_scc1 L_F_exit
  s_load_dwordx2 s[56:57], s[0:1], 96
  s_load_dwordx2 s[36:37], s[0:1], 8
  s_and_b32 s34, s2, 7
  s_bfe_u32 s81, s2, 0x20003
  v_lshrrev_b32 v58, 6, v0
  s_lshl2_add_u32 s30, s34, s81
  s_lshr_b32 s31, s2, 5
  v_and_b32 v54, 7, v0
  v_lshlrev_b32 v54, 4, v54
  v_readfirstlane_b32 s32, v58
  v_bfe_u32 v59, v0, 3, 3
  s_mov_b32 s54, 1280
  s_mov_b32 s55, 0x20000
  s_mov_b32 s46, 1966080
  s_mov_b32 s47, 0x20000
  s_movk_i32 s68, 6144
  s_mul_i32 s82, s34, 3
  s_add_u32 s82, s82, s31
  s_sub_u32 s82, s82, 5
  s_and_b32 s34, s32, 3
  s_mul_i32 s34, s34, 40
  s_mul_i32 s35, s81, 160
  s_add_u32 s34, s34, s35
  s_lshl_b32 s35, s34, 1
  v_lshl_add_u32 v3, v59, 3, s35
  v_lshl_add_u32 v61, v59, 1, s35
  s_mul_i32 s34, s34, 3072
  s_lshl_b32 s35, s82, 7
  s_add_u32 s34, s34, s35
  v_mul_u32_u24 v60, 3072, v59
  v_add_u32 v62, s34, v54
  v_lshl_add_u32 v2, v60, 2, v62
  v_add_u32 v30, v60, v62
  s_mov_b32 s9, 98304
  s_cmp_ge_u32 s32, 4
  s_waitcnt lgkmcnt(0)
  s_cselect_b32 s44, s18, s16
  s_cselect_b32 s45, s19, s17
  buffer_load_dwordx2 v[48:49], v3, s[52:55], 0 offen
  buffer_load_ushort v50, v61, s[52:55], 0 offen offset:64
  buffer_load_dwordx4 v[232:235], v2, s[44:47], 0 offen offset:0 nt
  buffer_load_dwordx4 v[236:239], v2, s[44:47], 0 offen offset:3072 nt
  buffer_load_dwordx4 v[240:243], v2, s[44:47], s68 offen offset:0 nt
  s_load_dword s33, s[56:57], 0
  s_load_dwordx2 s[40:41], s[0:1], 16
  s_load_dwordx2 s[48:49], s[0:1], 64
  s_load_dwordx2 s[60:61], s[0:1], 80
  s_load_dwordx2 s[64:65], s[0:1], 72
  s_mul_i32 s34, s30, 12582912
  s_add_u32 s34, s34, 11010048
  v_mul_u32_u24 v1, 384, v59
  v_add3_u32 v1, v1, v54, s34
  s_mov_b32 s38, 402653184
  s_mov_b32 s39, 0x20000
  s_mov_b32 s42, 402653184
  s_mov_b32 s43, 0x20000
  s_mov_b32 s58, 4194304
  s_mov_b32 s59, 0x20000
  s_mov_b32 s50, 1966080
  s_mov_b32 s51, 0x20000
  s_mov_b32 s62, 1280
  s_mov_b32 s63, 0x20000
  s_mov_b32 s66, 1280
  s_mov_b32 s67, 0x20000
  s_mov_b32 s79, 0
  s_mov_b32 s17, 0
  s_getreg_b32 s8, hwreg(HW_REG_XCC_ID, 0, 4)
  s_mov_b32 s80, 0x3fb8aa3b
  s_mov_b32 s20, 0x00ff00ff
  s_mov_b32 s21, 0xff00ff00
  v_and_b32 v58, 1, v0
  v_lshlrev_b32 v58, 4, v58
  v_mov_b32 v60, 0xffff
  v_lshlrev_b32 v60, v58, v60
  v_bfe_u32 v58, v0, 1, 2
  v_cmp_eq_u32 s[22:23], 0, v58
  v_cmp_eq_u32 s[24:25], 1, v58
  v_cmp_eq_u32 s[26:27], 2, v58
  v_cmp_eq_u32 s[28:29], 3, v58
  v_cndmask_b32 v4, 0, v60, s[22:23]
  v_cndmask_b32 v5, 0, v60, s[24:25]
  v_cndmask_b32 v6, 0, v60, s[26:27]
  v_cndmask_b32 v7, 0, v60, s[28:29]
  v_lshl_add_u32 v55, v59, 10, v54
  v_lshlrev_b32 v56, 1, v54
  v_lshl_add_u32 v56, v59, 2, v56
  v_bfe_u32 v58, v0, 4, 1
  v_lshlrev_b32 v58, 4, v58
  v_lshl_add_u32 v58, v54, 1, v58
  v_bfe_u32 v60, v0, 5, 1
  s_mul_i32 s34, s32, 1568
  v_mul_u32_u24 v52, 768, v60
  v_add3_u32 v52, v52, v58, s34
  s_mul_i32 s34, s32, 96
  v_mul_u32_u24 v53, 1568, v59
  v_and_b32 v61, 7, v0
  v_mul_u32_u24 v61, 12, v61
  v_add3_u32 v53, v53, v61, s34
  s_lshl_b32 s34, s32, 7
  s_lshl_b32 s35, s30, 13
  s_add_u32 s35, s35, s34
  s_add_u32 s72, s35, 4096
  s_add_u32 s76, s35, 4096
  s_lshl_b32 s35, s31, 10
  s_add_u32 s71, s72, s35
  s_add_u32 s75, s76, s35
  s_lshl_b32 s35, s30, 10
  s_add_u32 s74, s35, 458752
  s_lshl_b32 s35, s31, 7
  s_add_u32 s73, s74, s35
  s_lshl_b32 s35, s82, 12
  s_add_u32 s35, s35, s34
  s_add_u32 s76, s35, 327680
  s_lshl_b32 s35, s81, 10
  s_add_u32 s71, s76, s35
  s_mul_i32 s34, s32, 544
  s_add_u32 s34, s34, 12544
  v_lshlrev_b32 v28, 8, v60
  v_add3_u32 v28, v28, v58, s34
  s_lshl_b32 s34, s32, 5
  s_add_u32 s34, s34, 12544
  v_mul_u32_u24 v29, 544, v59
  v_lshrrev_b32 v61, 2, v54
  v_add3_u32 v29, v29, v61, s34
  s_cmp_eq_u32 s32, 0
  s_cselect_b32 s34, 0, 16777216
  v_and_b32 v226, 63, v0
  v_lshl_add_u32 v225, v226, 2, s34
  v_lshl_add_u32 v226, v226, 4, s34
  s_lshr_b32 s35, s31, 2
  s_lshl3_add_u32 s35, s35, s32
  s_and_b32 s34, s31, 3
  s_lshl2_add_u32 s35, s35, s34
  s_mul_i32 s34, s30, 53
  s_add_u32 s35, s35, s34
  s_and_b32 s34, s35, 511
  s_mul_i32 s70, s34, 3072
  s_add_u32 s35, s35, 64
  s_and_b32 s34, s35, 511
  s_mul_i32 s24, s34, 3072
  s_add_u32 s35, s35, 64
  s_and_b32 s34, s35, 511
  s_mul_i32 s25, s34, 3072
  s_add_u32 s35, s35, 64
  s_and_b32 s34, s35, 511
  s_mul_i32 s26, s34, 3072
  s_add_u32 s35, s35, 64
  s_and_b32 s34, s35, 511
  s_mul_i32 s27, s34, 3072
  s_add_u32 s35, s35, 64
  s_and_b32 s34, s35, 511
  s_mul_i32 s28, s34, 3072
  s_add_u32 s35, s35, 64
  s_and_b32 s34, s35, 511
  s_mul_i32 s29, s34, 3072
  s_add_u32 s35, s35, 64
  s_and_b32 s34, s35, 511
  s_mul_i32 s16, s34, 3072
  v_mov_b32 v40, 0
  v_mov_b32 v41, 0
  v_mov_b32 v42, 0
  v_mov_b32 v43, 0
  v_mov_b32 v44, 0
  v_mov_b32 v45, 0
  v_mov_b32 v46, 0
  v_mov_b32 v47, 0
  s_mov_b32 s14, 0x01000100
  s_mov_b32 s15, 0x03020302
  s_waitcnt vmcnt(3)
  v_perm_b32 v58, v48, v48, s14
  v_and_b32 v8, v58, v4
  v_and_b32 v9, v58, v5
  v_and_b32 v10, v58, v6
  v_and_b32 v11, v58, v7
  v_perm_b32 v58, v48, v48, s15
  v_and_b32 v12, v58, v4
  v_and_b32 v13, v58, v5
  v_and_b32 v14, v58, v6
  v_and_b32 v15, v58, v7
  s_waitcnt vmcnt(0)
  buffer_load_dwordx4 v[244:247], v2, s[44:47], s68 offen offset:3072 nt
  buffer_load_dwordx4 v[248:251], v30, s[44:47], s9 offen nt
  v_mfma_f32_16x16x32_bf16 v[16:19], v[8:11], v[232:235], 0
  v_perm_b32 v58, v49, v49, s14
  v_and_b32 v8, v58, v4
  v_and_b32 v9, v58, v5
  v_and_b32 v10, v58, v6
  v_and_b32 v11, v58, v7
  v_mfma_f32_16x16x32_bf16 v[16:19], v[12:15], v[236:239], v[16:19]
  v_perm_b32 v58, v49, v49, s15
  v_and_b32 v12, v58, v4
  v_and_b32 v13, v58, v5
  v_and_b32 v14, v58, v6
  v_and_b32 v15, v58, v7
  v_mfma_f32_16x16x32_bf16 v[16:19], v[8:11], v[240:243], v[16:19]
  v_perm_b32 v58, v50, v50, s14
  v_and_b32 v8, v58, v4
  v_and_b32 v9, v58, v5
  v_and_b32 v10, v58, v6
  v_and_b32 v11, v58, v7
  s_waitcnt vmcnt(0)
  buffer_load_dwordx4 v[64:67], v1, s[36:39], s70 offen offset:0 nt
  buffer_load_dwordx4 v[68:71], v1, s[36:39], s70 offen offset:128 nt
  buffer_load_dwordx4 v[72:75], v1, s[36:39], s70 offen offset:256 nt
  v_mfma_f32_16x16x32_bf16 v[16:19], v[12:15], v[244:247], v[16:19]
  v_mfma_f32_16x16x32_bf16 v[16:19], v[8:11], v[248:251], v[16:19]
  s_mov_b64 exec, s[20:21]
  s_nop 6
  ds_write_b128 v28, v[16:19] offset:0
  s_mov_b64 exec, -1
  s_waitcnt lgkmcnt(0)
  s_add_u32 s33, s33, 0x9e3779b9
  s_barrier
  ds_read2_b32 v[58:59], v29 offset0:0 offset1:64
  s_add_u32 s34, s33, s8
  v_mov_b32 v51, s34
  v_mov_b32 v50, 0
  s_waitcnt lgkmcnt(0)
  v_add_f32 v48, v58, v59
  s_nop 1
  v_permlane16_swap_b32 v48, v58
  v_add_f32 v48, v48, v58
  s_nop 1
  v_add_f32_dpp v48, v48, v48 row_ror:8 row_mask:0xf bank_mask:0xf
  s_nop 1
  v_permlane32_swap_b32 v48, v49
  s_mov_b64 exec, 0xff
  buffer_store_dwordx4 v[48:51], v54, s[56:59], s71 offen
  s_lshl_b32 s34, s32, 7
  v_add_u32 v62, s34, v54
  ds_write_b128 v62, v[48:51] offset:34560
  s_mov_b64 exec, -1
  s_lshr_b32 s6, s33, 26
  s_or_b32 s6, s6, 0x43300000
  s_lshl_b32 s7, s33, 6
  s_lshl_b32 s34, s82, 1
  s_add_u32 s34, s34, s81
  s_sub_u32 s34, s34, 2
  s_cmp_ge_u32 s81, 2
  s_cselect_b32 s34, s34, 64
  s_cmp_eq_u32 s32, 1
  s_cselect_b32 s34, s34, 64
  s_cmp_lt_u32 s34, 40
  s_cselect_b32 s34, s34, 16384
  s_lshl_b32 s34, s34, 10
  v_bfe_u32 v62, v0, 2, 2
  v_and_b32 v63, 3, v0
  v_lshlrev_b32 v63, 4, v63
  v_lshl_add_u32 v62, v62, 8, v63
  v_add_u32 v62, s34, v62
  v_mov_b32 v58, 0
  v_mov_b32 v59, 0
  v_mov_b32 v60, s7
  v_mov_b32 v61, s6
  s_mov_b32 s34, 786432
  s_mov_b64 exec, 0xffff
  buffer_store_dwordx4 v[58:61], v62, s[56:59], s34 offen sc1
  s_mov_b64 exec, -1
  s_waitcnt vmcnt(2)
  buffer_load_dwordx4 v[76:79], v1, s[36:39], s24 offen offset:0 nt
  buffer_load_dwordx4 v[80:83], v1, s[36:39], s24 offen offset:128 nt
  buffer_load_dwordx4 v[84:87], v1, s[36:39], s24 offen offset:256 nt
  buffer_load_dwordx4 v[208:211], v226, s[52:55], 0 offen
  buffer_load_dword v212, v225, s[52:55], 0 offen offset:1024
  buffer_load_dwordx4 v[216:219], v226, s[64:67], 0 offen
  buffer_load_dword v220, v225, s[64:67], 0 offen offset:1024
  s_waitcnt vmcnt(4)
  buffer_load_dwordx4 v[88:91], v1, s[36:39], s25 offen offset:0 nt
  buffer_load_dwordx4 v[92:95], v1, s[36:39], s25 offen offset:128 nt
  buffer_load_dwordx4 v[96:99], v1, s[36:39], s25 offen offset:256 nt
  s_waitcnt vmcnt(0)
  buffer_load_dwordx4 v[100:103], v1, s[36:39], s26 offen offset:0 nt
  buffer_load_dwordx4 v[104:107], v1, s[36:39], s26 offen offset:128 nt
  buffer_load_dwordx4 v[108:111], v1, s[36:39], s26 offen offset:256 nt
  s_cmp_lg_u32 s32, 0
  s_cbranch_scc1 L_F_nog
  v_mov_b32 v224, 0
  v_lshlrev_b32 v59, 16, v208
  v_lshlrev_b32 v60, 16, v216
  v_and_b32 v208, 0xffff0000, v208
  v_and_b32 v216, 0xffff0000, v216
  v_mul_f32 v59, v59, v60
  v_mul_f32 v60, v208, v216
  v_cvt_pk_bf16_f32 v59, v59, v60
  v_lshlrev_b32 v60, 16, v59
  v_and_b32 v59, 0xffff0000, v59
  v_add_f32 v224, v224, v60
  v_add_f32 v224, v224, v59
  v_lshlrev_b32 v59, 16, v209
  v_lshlrev_b32 v60, 16, v217
  v_and_b32 v209, 0xffff0000, v209
  v_and_b32 v217, 0xffff0000, v217
  v_mul_f32 v59, v59, v60
  v_mul_f32 v60, v209, v217
  v_cvt_pk_bf16_f32 v59, v59, v60
  v_lshlrev_b32 v60, 16, v59
  v_and_b32 v59, 0xffff0000, v59
  v_add_f32 v224, v224, v60
  v_add_f32 v224, v224, v59
  v_lshlrev_b32 v59, 16, v210
  v_lshlrev_b32 v60, 16, v218
  v_and_b32 v210, 0xffff0000, v210
  v_and_b32 v218, 0xffff0000, v218
  v_mul_f32 v59, v59, v60
  v_mul_f32 v60, v210, v218
  v_cvt_pk_bf16_f32 v59, v59, v60
  v_lshlrev_b32 v60, 16, v59
  v_and_b32 v59, 0xffff0000, v59
  v_add_f32 v224, v224, v60
  v_add_f32 v224, v224, v59
  v_lshlrev_b32 v59, 16, v211
  v_lshlrev_b32 v60, 16, v219
  v_and_b32 v211, 0xffff0000, v211
  v_and_b32 v219, 0xffff0000, v219
  v_mul_f32 v59, v59, v60
  v_mul_f32 v60, v211, v219
  v_cvt_pk_bf16_f32 v59, v59, v60
  v_lshlrev_b32 v60, 16, v59
  v_and_b32 v59, 0xffff0000, v59
  v_add_f32 v224, v224, v60
  v_add_f32 v224, v224, v59
  v_lshlrev_b32 v59, 16, v212
  v_lshlrev_b32 v60, 16, v220
  v_and_b32 v212, 0xffff0000, v212
  v_and_b32 v220, 0xffff0000, v220
  v_mul_f32 v59, v59, v60
  v_mul_f32 v60, v212, v220
  v_cvt_pk_bf16_f32 v59, v59, v60
  v_lshlrev_b32 v60, 16, v59
  v_and_b32 v59, 0xffff0000, v59
  v_add_f32 v224, v224, v60
  v_add_f32 v224, v224, v59
  s_nop 1
  v_add_f32_dpp v224, v224, v224 quad_perm:[1,0,3,2] row_mask:0xf bank_mask:0xf
  s_nop 1
  v_add_f32_dpp v224, v224, v224 quad_perm:[2,3,0,1] row_mask:0xf bank_mask:0xf
  s_nop 1
  v_add_f32_dpp v224, v224, v224 row_half_mirror row_mask:0xf bank_mask:0xf
  s_nop 1
  v_permlane32_swap_b32 v224, v59
  v_add_f32 v224, v224, v59
  s_nop 1
  v_permlane16_swap_b32 v224, v59
  v_add_f32 v224, v224, v59
  s_nop 1
  v_add_f32_dpp v224, v224, v224 row_ror:8 row_mask:0xf bank_mask:0xf
  v_cvt_pk_bf16_f32 v224, v224, v224
  v_lshlrev_b32 v224, 16, v224
  v_mul_f32 v224, 0xbfb8aa3b, v224
  v_exp_f32 v224, v224
  s_nop 0
  v_add_f32 v224, 1.0, v224
  v_rcp_f32 v224, v224
  s_nop 0
  v_cvt_pk_bf16_f32 v224, v224, v224
  v_lshlrev_b32 v224, 16, v224
  s_mov_b64 exec, 1
  ds_write_b32 v225, v224 offset:34496
  s_mov_b64 exec, -1
L_F_nog:
  s_waitcnt vmcnt(0)
  buffer_load_dwordx4 v[112:115], v1, s[36:39], s27 offen offset:0 nt
  buffer_load_dwordx4 v[116:119], v1, s[36:39], s27 offen offset:128 nt
  buffer_load_dwordx4 v[120:123], v1, s[36:39], s27 offen offset:256 nt
  v_mov_b32 v48, 0
  v_mov_b32 v49, 0
  v_mov_b32 v50, 0
  s_mov_b32 exec_hi, 0xff
  buffer_load_dwordx4 v[48:51], v55, s[56:59], s72 offen sc1
  s_mov_b64 exec, -1
  s_waitcnt vmcnt(1)
  buffer_load_dwordx4 v[124:127], v1, s[36:39], s28 offen offset:0 nt
  buffer_load_dwordx4 v[128:131], v1, s[36:39], s28 offen offset:128 nt
  buffer_load_dwordx4 v[132:135], v1, s[36:39], s28 offen offset:256 nt
  s_waitcnt vmcnt(0)
  buffer_load_dwordx4 v[136:139], v1, s[36:39], s29 offen offset:0 nt
  buffer_load_dwordx4 v[140:143], v1, s[36:39], s29 offen offset:128 nt
  buffer_load_dwordx4 v[144:147], v1, s[36:39], s29 offen offset:256 nt
  s_mov_b32 exec_hi, 0xff
L_F_qpoll_chk:
  v_subrev_u32 v58, s33, v51
  v_cmp_lt_u32 vcc, 15, v58
  s_cbranch_vccnz L_F_qpoll_retry
  v_cmp_ne_u32 vcc, s8, v58
  s_mov_b32 s3, 1
  s_cbranch_vccnz L_F_qpoll_remote
L_F_qpoll_back:
  s_mov_b64 exec, -1
  ds_bpermute_b32 v58, v56, v48
  ds_bpermute_b32 v59, v56, v49
  ds_bpermute_b32 v60, v56, v50
  s_waitcnt lgkmcnt(0)
  v_add_f32_dpp v58, v58, v58 quad_perm:[1,0,3,2] row_mask:0xf bank_mask:0xf
  v_add_f32_dpp v59, v59, v59 quad_perm:[1,0,3,2] row_mask:0xf bank_mask:0xf
  v_add_f32_dpp v60, v60, v60 quad_perm:[1,0,3,2] row_mask:0xf bank_mask:0xf
  v_add_f32_dpp v58, v58, v58 quad_perm:[2,3,0,1] row_mask:0xf bank_mask:0xf
  v_add_f32_dpp v59, v59, v59 quad_perm:[2,3,0,1] row_mask:0xf bank_mask:0xf
  v_add_f32_dpp v60, v60, v60 quad_perm:[2,3,0,1] row_mask:0xf bank_mask:0xf
  v_add_f32_dpp v58, v58, v58 row_half_mirror row_mask:0xf bank_mask:0xf
  v_add_f32_dpp v59, v59, v59 row_half_mirror row_mask:0xf bank_mask:0xf
  v_add_f32_dpp v60, v60, v60 row_half_mirror row_mask:0xf bank_mask:0xf
  v_cvt_pk_bf16_f32 v58, v58, v59
  v_cvt_pk_bf16_f32 v59, v60, v60
  v_lshrrev_b32 v60, 3, v0
  v_mul_u32_u24 v60, 6, v60
  s_mov_b32 exec_lo, 0x1010101
  s_mov_b32 exec_hi, 0x1010101
  ds_write_b16 v60, v58 offset:34048
  ds_write_b16_d16_hi v60, v58 offset:34050
  ds_write_b16 v60, v59 offset:34052
  s_mov_b64 exec, -1
  s_waitcnt lgkmcnt(0)
  s_barrier
  ds_read_b128 v[28:31], v54 offset:34048
  ds_read_b128 v[32:35], v54 offset:34176
  ds_read_b128 v[36:39], v54 offset:34304
  s_waitcnt lgkmcnt(0)
  v_dot2c_f32_bf16 v40, v64, v28
  v_dot2c_f32_bf16 v41, v76, v28
  v_dot2c_f32_bf16 v40, v65, v29
  v_dot2c_f32_bf16 v41, v77, v29
  v_dot2c_f32_bf16 v40, v66, v30
  v_dot2c_f32_bf16 v41, v78, v30
  v_dot2c_f32_bf16 v40, v67, v31
  v_dot2c_f32_bf16 v41, v79, v31
  v_dot2c_f32_bf16 v40, v68, v32
  v_dot2c_f32_bf16 v41, v80, v32
  v_dot2c_f32_bf16 v40, v69, v33
  v_dot2c_f32_bf16 v41, v81, v33
  v_dot2c_f32_bf16 v40, v70, v34
  v_dot2c_f32_bf16 v41, v82, v34
  v_dot2c_f32_bf16 v40, v71, v35
  v_dot2c_f32_bf16 v41, v83, v35
  v_dot2c_f32_bf16 v40, v72, v36
  v_dot2c_f32_bf16 v41, v84, v36
  v_dot2c_f32_bf16 v40, v73, v37
  v_dot2c_f32_bf16 v41, v85, v37
  v_dot2c_f32_bf16 v40, v74, v38
  v_dot2c_f32_bf16 v41, v86, v38
  v_dot2c_f32_bf16 v40, v75, v39
  v_dot2c_f32_bf16 v41, v87, v39
  s_nop 1
  v_add_f32_dpp v40, v40, v40 quad_perm:[1,0,3,2] row_mask:0xf bank_mask:0xf
  v_add_f32_dpp v41, v41, v41 quad_perm:[1,0,3,2] row_mask:0xf bank_mask:0xf
  s_nop 0
  v_add_f32_dpp v40, v40, v40 quad_perm:[2,3,0,1] row_mask:0xf bank_mask:0xf
  v_add_f32_dpp v41, v41, v41 quad_perm:[2,3,0,1] row_mask:0xf bank_mask:0xf
  s_nop 0
  v_add_f32_dpp v40, v40, v40 row_half_mirror row_mask:0xf bank_mask:0xf
  v_add_f32_dpp v41, v41, v41 row_half_mirror row_mask:0xf bank_mask:0xf
  v_cvt_pk_bf16_f32 v40, v40, v41
  v_and_b32 v41, 0xffff0000, v40
  v_lshlrev_b32 v40, 16, v40
  v_mul_f32 v40, 0x3d93cd3a, v40
  v_mul_f32 v41, 0x3d93cd3a, v41
  v_cvt_pk_bf16_f32 v40, v40, v41
  v_and_b32 v41, 0xffff0000, v40
  v_lshlrev_b32 v40, 16, v40
  s_waitcnt vmcnt(0)
  buffer_load_dwordx4 v[148:151], v1, s[36:39], s16 offen offset:0 nt
  buffer_load_dwordx4 v[152:155], v1, s[36:39], s16 offen offset:128 nt
  buffer_load_dwordx4 v[156:159], v1, s[36:39], s16 offen offset:256 nt
  v_dot2c_f32_bf16 v42, v88, v28
  v_dot2c_f32_bf16 v43, v100, v28
  v_dot2c_f32_bf16 v42, v89, v29
  v_dot2c_f32_bf16 v43, v101, v29
  v_dot2c_f32_bf16 v42, v90, v30
  v_dot2c_f32_bf16 v43, v102, v30
  v_dot2c_f32_bf16 v42, v91, v31
  v_dot2c_f32_bf16 v43, v103, v31
  v_dot2c_f32_bf16 v42, v92, v32
  v_dot2c_f32_bf16 v43, v104, v32
  v_dot2c_f32_bf16 v42, v93, v33
  v_dot2c_f32_bf16 v43, v105, v33
  v_dot2c_f32_bf16 v42, v94, v34
  v_dot2c_f32_bf16 v43, v106, v34
  v_dot2c_f32_bf16 v42, v95, v35
  v_dot2c_f32_bf16 v43, v107, v35
  v_dot2c_f32_bf16 v42, v96, v36
  v_dot2c_f32_bf16 v43, v108, v36
  v_dot2c_f32_bf16 v42, v97, v37
  v_dot2c_f32_bf16 v43, v109, v37
  v_dot2c_f32_bf16 v42, v98, v38
  v_dot2c_f32_bf16 v43, v110, v38
  v_dot2c_f32_bf16 v42, v99, v39
  v_dot2c_f32_bf16 v43, v111, v39
  s_nop 1
  v_add_f32_dpp v42, v42, v42 quad_perm:[1,0,3,2] row_mask:0xf bank_mask:0xf
  v_add_f32_dpp v43, v43, v43 quad_perm:[1,0,3,2] row_mask:0xf bank_mask:0xf
  s_nop 0
  v_add_f32_dpp v42, v42, v42 quad_perm:[2,3,0,1] row_mask:0xf bank_mask:0xf
  v_add_f32_dpp v43, v43, v43 quad_perm:[2,3,0,1] row_mask:0xf bank_mask:0xf
  s_nop 0
  v_add_f32_dpp v42, v42, v42 row_half_mirror row_mask:0xf bank_mask:0xf
  v_add_f32_dpp v43, v43, v43 row_half_mirror row_mask:0xf bank_mask:0xf
  v_cvt_pk_bf16_f32 v42, v42, v43
  v_and_b32 v43, 0xffff0000, v42
  v_lshlrev_b32 v42, 16, v42
  v_mul_f32 v42, 0x3d93cd3a, v42
  v_mul_f32 v43, 0x3d93cd3a, v43
  v_cvt_pk_bf16_f32 v42, v42, v43
  v_and_b32 v43, 0xffff0000, v42
  v_lshlrev_b32 v42, 16, v42
  v_dot2c_f32_bf16 v44, v112, v28
  v_dot2c_f32_bf16 v45, v124, v28
  v_dot2c_f32_bf16 v44, v113, v29
  v_dot2c_f32_bf16 v45, v125, v29
  v_dot2c_f32_bf16 v44, v114, v30
  v_dot2c_f32_bf16 v45, v126, v30
  v_dot2c_f32_bf16 v44, v115, v31
  v_dot2c_f32_bf16 v45, v127, v31
  v_dot2c_f32_bf16 v44, v116, v32
  v_dot2c_f32_bf16 v45, v128, v32
  v_dot2c_f32_bf16 v44, v117, v33
  v_dot2c_f32_bf16 v45, v129, v33
  v_dot2c_f32_bf16 v44, v118, v34
  v_dot2c_f32_bf16 v45, v130, v34
  v_dot2c_f32_bf16 v44, v119, v35
  v_dot2c_f32_bf16 v45, v131, v35
  v_dot2c_f32_bf16 v44, v120, v36
  v_dot2c_f32_bf16 v45, v132, v36
  v_dot2c_f32_bf16 v44, v121, v37
  v_dot2c_f32_bf16 v45, v133, v37
  v_dot2c_f32_bf16 v44, v122, v38
  v_dot2c_f32_bf16 v45, v134, v38
  v_dot2c_f32_bf16 v44, v123, v39
  v_dot2c_f32_bf16 v45, v135, v39
  s_nop 1
  v_add_f32_dpp v44, v44, v44 quad_perm:[1,0,3,2] row_mask:0xf bank_mask:0xf
  v_add_f32_dpp v45, v45, v45 quad_perm:[1,0,3,2] row_mask:0xf bank_mask:0xf
  s_nop 0
  v_add_f32_dpp v44, v44, v44 quad_perm:[2,3,0,1] row_mask:0xf bank_mask:0xf
  v_add_f32_dpp v45, v45, v45 quad_perm:[2,3,0,1] row_mask:0xf bank_mask:0xf
  s_nop 0
  v_add_f32_dpp v44, v44, v44 row_half_mirror row_mask:0xf bank_mask:0xf
  v_add_f32_dpp v45, v45, v45 row_half_mirror row_mask:0xf bank_mask:0xf
  v_cvt_pk_bf16_f32 v44, v44, v45
  v_and_b32 v45, 0xffff0000, v44
  v_lshlrev_b32 v44, 16, v44
  v_mul_f32 v44, 0x3d93cd3a, v44
  v_mul_f32 v45, 0x3d93cd3a, v45
  v_cvt_pk_bf16_f32 v44, v44, v45
  v_and_b32 v45, 0xffff0000, v44
  v_lshlrev_b32 v44, 16, v44
  s_waitcnt vmcnt(0)
  buffer_load_dwordx4 v[160:163], v1, s[40:43], s70 offen offset:0 nt
  buffer_load_dwordx4 v[164:167], v1, s[40:43], s70 offen offset:128 nt
  buffer_load_dwordx4 v[168:171], v1, s[40:43], s70 offen offset:256 nt
  v_dot2c_f32_bf16 v46, v136, v28
  v_dot2c_f32_bf16 v47, v148, v28
  v_dot2c_f32_bf16 v46, v137, v29
  v_dot2c_f32_bf16 v47, v149, v29
  v_dot2c_f32_bf16 v46, v138, v30
  v_dot2c_f32_bf16 v47, v150, v30
  v_dot2c_f32_bf16 v46, v139, v31
  v_dot2c_f32_bf16 v47, v151, v31
  v_dot2c_f32_bf16 v46, v140, v32
  v_dot2c_f32_bf16 v47, v152, v32
  v_dot2c_f32_bf16 v46, v141, v33
  v_dot2c_f32_bf16 v47, v153, v33
  v_dot2c_f32_bf16 v46, v142, v34
  v_dot2c_f32_bf16 v47, v154, v34
  v_dot2c_f32_bf16 v46, v143, v35
  v_dot2c_f32_bf16 v47, v155, v35
  v_dot2c_f32_bf16 v46, v144, v36
  v_dot2c_f32_bf16 v47, v156, v36
  v_dot2c_f32_bf16 v46, v145, v37
  v_dot2c_f32_bf16 v47, v157, v37
  v_dot2c_f32_bf16 v46, v146, v38
  v_dot2c_f32_bf16 v47, v158, v38
  v_dot2c_f32_bf16 v46, v147, v39
  v_dot2c_f32_bf16 v47, v159, v39
  s_nop 1
  v_add_f32_dpp v46, v46, v46 quad_perm:[1,0,3,2] row_mask:0xf bank_mask:0xf
  v_add_f32_dpp v47, v47, v47 quad_perm:[1,0,3,2] row_mask:0xf bank_mask:0xf
  s_nop 0
  v_add_f32_dpp v46, v46, v46 quad_perm:[2,3,0,1] row_mask:0xf bank_mask:0xf
  v_add_f32_dpp v47, v47, v47 quad_perm:[2,3,0,1] row_mask:0xf bank_mask:0xf
  s_nop 0
  v_add_f32_dpp v46, v46, v46 row_half_mirror row_mask:0xf bank_mask:0xf
  v_add_f32_dpp v47, v47, v47 row_half_mirror row_mask:0xf bank_mask:0xf
  v_cvt_pk_bf16_f32 v46, v46, v47
  v_and_b32 v47, 0xffff0000, v46
  v_lshlrev_b32 v46, 16, v46
  v_mul_f32 v46, 0x3d93cd3a, v46
  v_mul_f32 v47, 0x3d93cd3a, v47
  v_cvt_pk_bf16_f32 v46, v46, v47
  v_and_b32 v47, 0xffff0000, v46
  v_lshlrev_b32 v46, 16, v46
  v_max3_f32 v58, v40, v41, v42
  v_max3_f32 v59, v43, v44, v45
  v_max3_f32 v58, v58, v46, v47
  v_max_f32 v58, v58, v59
  s_nop 1
  v_permlane32_swap_b32 v58, v59
  v_max_f32 v58, v58, v59
  s_nop 1
  v_permlane16_swap_b32 v58, v59
  v_max_f32 v58, v58, v59
  s_nop 1
  v_max_f32_dpp v58, v58, v58 row_ror:8 row_mask:0xf bank_mask:0xf
  v_mul_f32 v48, s80, v58
  s_lshl_b32 s35, s32, 3
  v_readfirstlane_b32 s34, v48
  v_mov_b32 v62, s35
  v_lshrrev_b32 v63, 1, v54
  v_mov_b32 v57, s34
  v_fma_f32 v40, v40, s80, -v57
  v_fma_f32 v41, v41, s80, -v57
  v_fma_f32 v42, v42, s80, -v57
  v_fma_f32 v43, v43, s80, -v57
  v_fma_f32 v44, v44, s80, -v57
  v_fma_f32 v45, v45, s80, -v57
  v_fma_f32 v46, v46, s80, -v57
  v_fma_f32 v47, v47, s80, -v57
  v_exp_f32 v40, v40
  v_exp_f32 v41, v41
  v_exp_f32 v42, v42
  v_exp_f32 v43, v43
  v_exp_f32 v44, v44
  v_exp_f32 v45, v45
  v_exp_f32 v46, v46
  v_exp_f32 v47, v47
  v_add_f32 v58, v40, v41
  v_add_f32 v59, v42, v43
  v_add_f32 v60, v44, v45
  v_add_f32 v61, v46, v47
  v_add_f32 v58, v58, v59
  v_add_f32 v60, v60, v61
  v_add_f32 v49, v58, v60
  s_nop 1
  v_permlane32_swap_b32 v49, v59
  v_add_f32 v49, v49, v59
  s_nop 1
  v_permlane16_swap_b32 v49, v59
  v_add_f32 v49, v49, v59
  s_nop 1
  v_add_f32_dpp v49, v49, v49 row_ror:8 row_mask:0xf bank_mask:0xf
  s_mov_b64 exec, 0x1
  ds_write_b64 v62, v[48:49] offset:34432
  s_mov_b64 exec, -1
  s_waitcnt lgkmcnt(0)
  s_barrier
  ds_read_b64 v[58:59], v63 offset:34432
  v_mov_b32 v60, 0
  ds_read_b32 v50, v60 offset:34496
  v_mov_b32 v51, s33
  s_cmp_eq_u32 s32, 0
  s_cselect_b32 s34, 0, 16777216
  v_add_u32 v62, s34, v54
  s_waitcnt lgkmcnt(0)
  v_mov_b32 v48, v58
  s_nop 1
  v_max_f32_dpp v48, v48, v48 quad_perm:[1,0,3,2] row_mask:0xf bank_mask:0xf
  s_nop 1
  v_max_f32_dpp v48, v48, v48 quad_perm:[2,3,0,1] row_mask:0xf bank_mask:0xf
  s_nop 1
  v_max_f32_dpp v48, v48, v48 row_half_mirror row_mask:0xf bank_mask:0xf
  v_sub_f32 v58, v58, v48
  v_sub_f32 v57, v57, v48
  v_exp_f32 v58, v58
  v_exp_f32 v57, v57
  v_mul_f32 v49, v58, v59
  v_mul_f32 v40, v40, v57
  v_mul_f32 v41, v41, v57
  v_add_f32_dpp v49, v49, v49 quad_perm:[1,0,3,2] row_mask:0xf bank_mask:0xf
  v_mul_f32 v42, v42, v57
  v_mul_f32 v43, v43, v57
  v_add_f32_dpp v49, v49, v49 quad_perm:[2,3,0,1] row_mask:0xf bank_mask:0xf
  v_mul_f32 v44, v44, v57
  v_mul_f32 v45, v45, v57
  v_add_f32_dpp v49, v49, v49 row_half_mirror row_mask:0xf bank_mask:0xf
  v_mul_f32 v46, v46, v57
  v_mul_f32 v47, v47, v57
  s_mov_b64 exec, 0xff
  s_cmp_lg_u32 s3, 0
  s_cbranch_scc0 L_F_pubml_far
  buffer_store_dwordx4 v[48:51], v62, s[56:59], s73 offen
L_F_pubml_done:
  s_mov_b64 exec, -1
  v_cvt_pk_bf16_f32 v40, v40, v40
  v_cvt_pk_bf16_f32 v41, v41, v41
  v_cvt_pk_bf16_f32 v42, v42, v42
  v_cvt_pk_bf16_f32 v43, v43, v43
  v_cvt_pk_bf16_f32 v44, v44, v44
  v_cvt_pk_bf16_f32 v45, v45, v45
  v_cvt_pk_bf16_f32 v46, v46, v46
  v_cvt_pk_bf16_f32 v47, v47, v47
  v_sub_f32 v57, 1.0, v50
  v_cvt_pk_bf16_f32 v57, v57, v57
  v_lshlrev_b32 v57, 16, v57
  v_and_b32 v8, v40, v4
  v_and_b32 v9, v40, v5
  v_and_b32 v10, v40, v6
  v_and_b32 v11, v40, v7
  s_waitcnt vmcnt(1)
  buffer_load_dwordx4 v[172:175], v1, s[40:43], s24 offen offset:0 nt
  buffer_load_dwordx4 v[176:179], v1, s[40:43], s24 offen offset:128 nt
  buffer_load_dwordx4 v[180:183], v1, s[40:43], s24 offen offset:256 nt
  v_bfe_u32 v59, v0, 3, 3
  v_bfe_u32 v58, v0, 4, 1
  v_lshlrev_b32 v58, 4, v58
  v_lshl_add_u32 v58, v54, 1, v58
  v_bfe_u32 v60, v0, 5, 1
  s_lshr_b32 s34, s32, 1
  s_mul_i32 s34, s34, 3136
  s_and_b32 s35, s32, 1
  s_mul_i32 s35, s35, 1536
  s_add_u32 s34, s34, s35
  s_add_u32 s34, s34, 21248
  v_mul_u32_u24 v89, 768, v60
  v_add3_u32 v89, v89, v58, s34
  v_and_b32 v61, 1, v0
  v_lshl_add_u32 v61, v60, 1, v61
  v_mul_u32_u24 v90, 3136, v61
  v_and_b32 v61, 30, v0
  s_lshl_b32 s34, s32, 6
  s_add_u32 s34, s34, 21248
  v_lshl_add_u32 v90, v61, 1, v90
  v_add_u32 v90, s34, v90
  v_lshl_add_u32 v149, v60, 8, v61
  v_lshrrev_b32 v61, 1, v54
  v_lshl_add_u32 v148, v59, 8, v61
  v_mul_u32_u24 v61, 7168, v60
  v_add_u32 v148, v148, v61
  v_mov_b32 v152, 0
  v_mov_b32 v153, 0x3ff00000
  s_mul_i32 s78, s81, 12
  s_min_u32 s78, s78, 32
  s_lshl_b32 s34, s82, 6
  s_lshl_b32 s35, s32, 3
  s_add_u32 s34, s34, s35
  s_mul_i32 s34, s34, 1280
  s_lshl_b32 s35, s78, 5
  s_add_u32 s34, s34, s35
  v_mul_u32_u24 v88, 1280, v59
  v_add3_u32 v88, v88, v54, s34
  s_cmp_ge_u32 s81, 2
  s_cselect_b32 s34, 16777216, 0
  s_cselect_b32 s23, 0, -1
  v_add_u32 v96, s34, v88
  s_cmp_ge_u32 s32, 4
  s_cselect_b32 s23, 0, s23
  s_mov_b32 s22, -1
  s_add_u32 s78, s78, s32
  s_lshl_b32 s77, s78, 10
  s_add_u32 s77, s77, 786432
  s_lshl_b32 s78, s78, 5
  s_add_u32 s5, s33, 16
  v_mfma_f32_16x16x32_bf16 v[16:19], v[8:11], v[160:163], 0
  v_and_b32 v12, v41, v4
  v_and_b32 v13, v41, v5
  v_and_b32 v14, v41, v6
  v_and_b32 v15, v41, v7
  v_mfma_f32_16x16x32_bf16 v[20:23], v[8:11], v[164:167], 0
  v_mfma_f32_16x16x32_bf16 v[24:27], v[8:11], v[168:171], 0
  v_mov_b32 v48, 0
  v_mov_b32 v49, 0
  v_mov_b32 v50, 0
  s_mov_b32 exec_hi, 0x0
  buffer_load_dwordx4 v[48:51], v55, s[56:59], s76 offen sc1
  s_mov_b64 exec, -1
  s_waitcnt vmcnt(1)
  buffer_load_dwordx4 v[184:187], v1, s[40:43], s25 offen offset:0 nt
  buffer_load_dwordx4 v[188:191], v1, s[40:43], s25 offen offset:128 nt
  buffer_load_dwordx4 v[192:195], v1, s[40:43], s25 offen offset:256 nt
  v_mfma_f32_16x16x32_bf16 v[16:19], v[12:15], v[172:175], v[16:19]
  v_and_b32 v8, v42, v4
  v_and_b32 v9, v42, v5
  v_and_b32 v10, v42, v6
  v_and_b32 v11, v42, v7
  v_mfma_f32_16x16x32_bf16 v[20:23], v[12:15], v[176:179], v[20:23]
  v_mfma_f32_16x16x32_bf16 v[24:27], v[12:15], v[180:183], v[24:27]
  s_waitcnt vmcnt(0)
  buffer_load_dwordx4 v[196:199], v1, s[40:43], s26 offen offset:0 nt
  buffer_load_dwordx4 v[200:203], v1, s[40:43], s26 offen offset:128 nt
  buffer_load_dwordx4 v[204:207], v1, s[40:43], s26 offen offset:256 nt
  s_mov_b32 exec_hi, 0x0
L_F_hpoll_chk:
  v_subrev_u32 v58, s33, v51
  v_cmp_lt_u32 vcc, 15, v58
  s_cbranch_vccnz L_F_hpoll_retry
  v_cmp_ne_u32 vcc, s8, v58
  s_cbranch_vccnz L_F_hpoll_remote
L_F_hpoll_back:
  s_mov_b64 exec, -1
  ds_bpermute_b32 v58, v56, v48
  ds_bpermute_b32 v59, v56, v49
  s_waitcnt lgkmcnt(0)
  v_add_f32_dpp v58, v58, v58 quad_perm:[1,0,3,2] row_mask:0xf bank_mask:0xf
  v_add_f32_dpp v59, v59, v59 quad_perm:[1,0,3,2] row_mask:0xf bank_mask:0xf
  s_nop 0
  v_add_f32_dpp v58, v58, v58 quad_perm:[2,3,0,1] row_mask:0xf bank_mask:0xf
  v_add_f32_dpp v59, v59, v59 quad_perm:[2,3,0,1] row_mask:0xf bank_mask:0xf
  s_nop 0
  v_add_f32_dpp v58, v58, v58 row_half_mirror row_mask:0xf bank_mask:0xf
  v_add_f32_dpp v59, v59, v59 row_half_mirror row_mask:0xf bank_mask:0xf
  v_cvt_pk_bf16_f32 v58, v58, v59
  v_and_b32 v59, 0xffff0000, v58
  v_lshlrev_b32 v58, 16, v58
  v_mul_f32 v60, 0xbfb8aa3b, v58
  v_exp_f32 v60, v60
  s_nop 0
  v_add_f32 v60, 1.0, v60
  v_rcp_f32 v60, v60
  s_nop 0
  v_mul_f32 v58, v58, v60
  v_cvt_pk_bf16_f32 v58, v58, v58
  v_lshlrev_b32 v58, 16, v58
  v_mul_f32 v58, v58, v59
  v_cvt_pk_bf16_f32 v58, v58, v58
  v_and_b32 v92, v58, v4
  v_and_b32 v93, v58, v5
  v_and_b32 v94, v58, v6
  v_and_b32 v95, v58, v7
  v_mfma_f32_16x16x32_bf16 v[16:19], v[8:11], v[184:187], v[16:19]
  v_and_b32 v12, v43, v4
  v_and_b32 v13, v43, v5
  v_and_b32 v14, v43, v6
  v_and_b32 v15, v43, v7
  v_mfma_f32_16x16x32_bf16 v[20:23], v[8:11], v[188:191], v[20:23]
  v_mfma_f32_16x16x32_bf16 v[24:27], v[8:11], v[192:195], v[24:27]
  s_waitcnt vmcnt(0)
  buffer_load_dwordx4 v[208:211], v1, s[40:43], s27 offen offset:0 nt
  buffer_load_dwordx4 v[212:215], v1, s[40:43], s27 offen offset:128 nt
  buffer_load_dwordx4 v[216:219], v1, s[40:43], s27 offen offset:256 nt
  v_mfma_f32_16x16x32_bf16 v[16:19], v[12:15], v[196:199], v[16:19]
  v_and_b32 v8, v44, v4
  v_and_b32 v9, v44, v5
  v_and_b32 v10, v44, v6
  v_and_b32 v11, v44, v7
  v_mfma_f32_16x16x32_bf16 v[20:23], v[12:15], v[200:203], v[20:23]
  v_mfma_f32_16x16x32_bf16 v[24:27], v[12:15], v[204:207], v[24:27]
  s_waitcnt vmcnt(0)
  buffer_load_dwordx4 v[220:223], v1, s[40:43], s28 offen offset:0 nt
  buffer_load_dwordx4 v[224:227], v1, s[40:43], s28 offen offset:128 nt
  buffer_load_dwordx4 v[228:231], v1, s[40:43], s28 offen offset:256 nt
  v_mfma_f32_16x16x32_bf16 v[16:19], v[8:11], v[208:211], v[16:19]
  v_and_b32 v12, v45, v4
  v_and_b32 v13, v45, v5
  v_and_b32 v14, v45, v6
  v_and_b32 v15, v45, v7
  v_mfma_f32_16x16x32_bf16 v[20:23], v[8:11], v[212:215], v[20:23]
  v_mfma_f32_16x16x32_bf16 v[24:27], v[8:11], v[216:219], v[24:27]
  s_waitcnt vmcnt(0)
  buffer_load_dwordx4 v[232:235], v1, s[40:43], s29 offen offset:0 nt
  buffer_load_dwordx4 v[236:239], v1, s[40:43], s29 offen offset:128 nt
  buffer_load_dwordx4 v[240:243], v1, s[40:43], s29 offen offset:256 nt
  v_mfma_f32_16x16x32_bf16 v[16:19], v[12:15], v[220:223], v[16:19]
  v_and_b32 v8, v46, v4
  v_and_b32 v9, v46, v5
  v_and_b32 v10, v46, v6
  v_and_b32 v11, v46, v7
  v_mfma_f32_16x16x32_bf16 v[20:23], v[12:15], v[224:227], v[20:23]
  v_mfma_f32_16x16x32_bf16 v[24:27], v[12:15], v[228:231], v[24:27]
  s_waitcnt vmcnt(0)
  buffer_load_dwordx4 v[244:247], v1, s[40:43], s16 offen offset:0 nt
  buffer_load_dwordx4 v[248:251], v1, s[40:43], s16 offen offset:128 nt
  buffer_load_dwordx4 v[252:255], v1, s[40:43], s16 offen offset:256 nt
  v_mfma_f32_16x16x32_bf16 v[16:19], v[8:11], v[232:235], v[16:19]
  v_and_b32 v12, v47, v4
  v_and_b32 v13, v47, v5
  v_and_b32 v14, v47, v6
  v_and_b32 v15, v47, v7
  v_mfma_f32_16x16x32_bf16 v[20:23], v[8:11], v[236:239], v[20:23]
  v_mfma_f32_16x16x32_bf16 v[24:27], v[8:11], v[240:243], v[24:27]
  s_waitcnt vmcnt(0)
  buffer_load_dwordx4 v[64:67], v88, s[48:51], 0 offen offset:0 nt
  buffer_load_dwordx4 v[68:71], v88, s[48:51], 0 offen offset:128 nt
  buffer_load_dwordx4 v[72:75], v96, s[48:51], 0 offen offset:256 nt
  v_mfma_f32_16x16x32_bf16 v[16:19], v[12:15], v[244:247], v[16:19]
  v_mfma_f32_16x16x32_bf16 v[20:23], v[12:15], v[248:251], v[20:23]
  v_mfma_f32_16x16x32_bf16 v[24:27], v[12:15], v[252:255], v[24:27]
  s_mov_b64 exec, s[20:21]
  s_nop 4
  ds_write_b128 v52, v[16:19] offset:0
  ds_write_b128 v52, v[20:23] offset:256
  ds_write_b128 v52, v[24:27] offset:512
  s_mov_b64 exec, -1
  s_waitcnt lgkmcnt(0)
  s_barrier
  ds_read2_b32 v[58:59], v53 offset0:0 offset1:192
  ds_read2_b32 v[60:61], v53 offset0:1 offset1:193
  ds_read2_b32 v[62:63], v53 offset0:2 offset1:194
  v_mov_b32 v51, s5
  s_cmp_lg_u32 s3, 0
  s_waitcnt lgkmcnt(2)
  v_add_f32 v48, v58, v59
  s_waitcnt lgkmcnt(1)
  v_add_f32 v49, v60, v61
  s_waitcnt lgkmcnt(0)
  v_add_f32 v50, v62, v63
  v_permlane32_swap_b32 v48, v58
  v_permlane32_swap_b32 v49, v59
  v_permlane32_swap_b32 v50, v60
  v_add_f32 v48, v48, v58
  v_add_f32 v49, v49, v59
  v_add_f32 v50, v50, v60
  v_permlane16_swap_b32 v48, v58
  v_permlane16_swap_b32 v49, v59
  v_permlane16_swap_b32 v50, v60
  v_add_f32 v48, v48, v58
  v_add_f32 v49, v49, v59
  v_add_f32 v50, v50, v60
  v_add_f32_dpp v48, v48, v48 row_ror:8 row_mask:0xf bank_mask:0xf
  v_add_f32_dpp v49, v49, v49 row_ror:8 row_mask:0xf bank_mask:0xf
  v_add_f32_dpp v50, v50, v50 row_ror:8 row_mask:0xf bank_mask:0xf
  s_mov_b64 exec, 0xff
  s_cbranch_scc0 L_F_pubo_far
  buffer_store_dwordx4 v[48:51], v54, s[56:59], s75 offen
L_F_pubo_done:
  s_mov_b64 exec, -1
  s_waitcnt vmcnt(3)
  v_mfma_f32_16x16x32_bf16 v[16:19], v[92:95], v[64:67], 0
  s_waitcnt vmcnt(2)
  v_mfma_f32_16x16x32_bf16 v[20:23], v[92:95], v[68:71], 0
  s_waitcnt vmcnt(1)
  v_mfma_f32_16x16x32_bf16 v[24:27], v[92:95], v[72:75], 0
  s_mov_b64 exec, s[20:21]
  s_nop 2
  ds_write_b128 v89, v[16:19] offset:0
  s_nop 0
  ds_write_b128 v89, v[20:23] offset:256
  s_nop 0
  ds_write_b128 v89, v[24:27] offset:512
  s_mov_b64 exec, -1
  s_waitcnt lgkmcnt(0)
  s_barrier
  ds_read2st64_b32 v[92:93], v90 offset0:0 offset1:3
  ds_read2st64_b32 v[94:95], v90 offset0:6 offset1:9
  ds_read2st64_b32 v[96:97], v90 offset0:2 offset1:5
  ds_read2st64_b32 v[98:99], v90 offset0:8 offset1:11
  s_waitcnt lgkmcnt(0)
  v_add_f32 v92, v92, v93
  v_add_f32 v94, v94, v95
  v_add_f32 v96, v96, v97
  v_add_f32 v98, v98, v99
  v_add_f32 v92, v92, v94
  v_add_f32 v96, v96, v98
  s_nop 1
  v_permlane32_swap_b32 v92, v96
  v_add_f32 v92, v92, v96
  s_nop 1
  v_add_f32_dpp v92, v92, v92 quad_perm:[1,0,3,2] row_mask:0xf bank_mask:0xf
  s_mov_b32 exec_lo, 0x55555555
  s_mov_b32 exec_hi, 0x55555555
  v_mul_f32 v92, v92, v57
  v_cvt_f64_f32 v[152:153], v92
  s_mov_b64 exec, s[22:23]
L_F_acc:
  buffer_atomic_add_f64 v[152:153], v148, s[56:59], s77 offen sc0 sc1
  v_cvt_f64_f32 v[150:151], v92
  s_mov_b32 s4, 0xaaaaaaaa
  s_mov_b32 s5, 0xaaaaaaaa
  s_add_u32 s79, s79, 1
  s_waitcnt vmcnt(0)
  v_add_f64 v[58:59], v[152:153], v[150:151]
  v_subrev_u32 v60, s7, v152
  v_cmp_ne_u32 s[18:19], s6, v153
  v_cvt_f32_f64 v58, v[58:59]
  v_cmp_lt_u32 s[14:15], 55, v60
  v_cmp_eq_u32 vcc, 55, v60
  v_cvt_pk_bf16_f32 v58, v58, v58
  s_andn2_b64 vcc, vcc, s[18:19]
  s_and_b64 vcc, vcc, s[4:5]
  s_lshr_b64 exec, vcc, 1
  s_cbranch_execz L_F_notlast
  buffer_store_short v58, v149, s[60:63], s78 offen
L_F_notlast:
  s_or_b64 s[18:19], s[18:19], s[14:15]
  s_and_b64 s[18:19], s[18:19], s[4:5]
  s_cbranch_scc1 L_F_again
  s_endpgm
L_F_qpoll_remote:
  s_cmp_lg_u32 s17, 0
  s_cbranch_scc1 L_F_qpoll_rm_np
  s_mov_b32 s17, 1
  s_mov_b64 s[18:19], exec
  s_mov_b64 exec, 0xff
  s_lshl_b32 s34, s32, 7
  v_add_u32 v62, s34, v54
  ds_read_b128 v[58:61], v62 offset:34560
  s_waitcnt lgkmcnt(0)
  buffer_store_dwordx4 v[58:61], v54, s[56:59], s71 offen sc1
  s_waitcnt vmcnt(0)
  s_mov_b64 exec, s[18:19]
L_F_qpoll_rm_np:
  s_mov_b32 s3, 0
  s_branch L_F_qpoll_back
L_F_qpoll_retry:
  s_cmp_lg_u32 s17, 0
  s_cbranch_scc1 L_F_qpoll_rt_np
  s_mov_b32 s17, 1
  s_mov_b64 s[18:19], exec
  s_mov_b64 exec, 0xff
  s_lshl_b32 s34, s32, 7
  v_add_u32 v62, s34, v54
  ds_read_b128 v[58:61], v62 offset:34560
  s_waitcnt lgkmcnt(0)
  buffer_store_dwordx4 v[58:61], v54, s[56:59], s71 offen sc1
  s_waitcnt vmcnt(0)
  s_mov_b64 exec, s[18:19]
L_F_qpoll_rt_np:
  buffer_load_dwordx4 v[48:51], v55, s[56:59], s72 offen sc1
  s_add_u32 s79, s79, 1
  s_cmp_gt_u32 s79, 8388608
  s_cbranch_scc1 L_F_exit
  s_waitcnt vmcnt(0)
  s_branch L_F_qpoll_chk
L_F_pubml_far:
  buffer_store_dwordx4 v[48:51], v62, s[56:59], s73 offen sc1
  s_branch L_F_pubml_done
L_F_hpoll_remote:
  s_cmp_lg_u32 s17, 0
  s_cbranch_scc1 L_F_hpoll_rm_np
  s_mov_b32 s17, 1
  s_mov_b64 s[18:19], exec
  s_mov_b64 exec, 0xff
  s_lshl_b32 s34, s32, 7
  v_add_u32 v62, s34, v54
  ds_read_b128 v[58:61], v62 offset:34560
  s_waitcnt lgkmcnt(0)
  buffer_store_dwordx4 v[58:61], v54, s[56:59], s71 offen sc1
  s_waitcnt vmcnt(0)
  s_mov_b64 exec, s[18:19]
L_F_hpoll_rm_np:
  s_branch L_F_hpoll_back
L_F_hpoll_retry:
  s_cmp_lg_u32 s17, 0
  s_cbranch_scc1 L_F_hpoll_rt_np
  s_mov_b32 s17, 1
  s_mov_b64 s[18:19], exec
  s_mov_b64 exec, 0xff
  s_lshl_b32 s34, s32, 7
  v_add_u32 v62, s34, v54
  ds_read_b128 v[58:61], v62 offset:34560
  s_waitcnt lgkmcnt(0)
  buffer_store_dwordx4 v[58:61], v54, s[56:59], s71 offen sc1
  s_waitcnt vmcnt(0)
  s_mov_b64 exec, s[18:19]
L_F_hpoll_rt_np:
  buffer_load_dwordx4 v[48:51], v55, s[56:59], s76 offen sc1
  s_add_u32 s79, s79, 1
  s_cmp_gt_u32 s79, 8388608
  s_cbranch_scc1 L_F_exit
  s_waitcnt vmcnt(0)
  s_branch L_F_hpoll_chk
L_F_pubo_far:
  buffer_store_dwordx4 v[48:51], v54, s[56:59], s75 offen sc1
  s_branch L_F_pubo_done
L_F_again:
  s_mov_b64 exec, s[18:19]
  v_mov_b32 v152, 0
  v_mov_b32 v153, 0x3ff00000
  s_lshr_b64 exec, s[18:19], 1
  v_cvt_f64_f32 v[152:153], v92
  s_or_b64 exec, exec, s[18:19]
  s_cmp_gt_u32 s79, 8388608
  s_cbranch_scc0 L_F_acc
L_F_exit:
  s_endpgm
.section .rodata,"a"
.p2align 6
.amdhsa_kernel gated_mix__sliding_block_cached__glu_gated_swiglu__decode_kernel
  .amdhsa_next_free_vgpr 256
  .amdhsa_next_free_sgpr 96
  .amdhsa_accum_offset 256
  .amdhsa_group_segment_fixed_size 0
  .amdhsa_kernarg_size 104
  .amdhsa_user_sgpr_count 2
  .amdhsa_user_sgpr_kernarg_segment_ptr 1
  .amdhsa_system_sgpr_workgroup_id_x 1
.end_amdhsa_kernel
```
